```python
import torch

def _softmax(x, axis=-1):
    return torch.softmax(x, dim=axis)
def _gelu(x):
    return torch.nn.functional.gelu(x, approximate="tanh")
def _silu(x):
    return torch.nn.functional.silu(x)
def _sigmoid(x):
    return torch.sigmoid(x)
def _layernorm(x, axis=-1, eps=1e-5):
    m = x.mean(dim=axis, keepdim=True)
    v = x.var(dim=axis, keepdim=True, unbiased=False)
    return (x - m) / torch.sqrt(v + eps)
def _scatter_add(tgt, idx, src, axis=0):
    return tgt.clone().index_add_(axis, idx, src)
def _segment_sum(src, seg, n):
    out = torch.zeros((n,) + src.shape[1:], dtype=src.dtype)
    return out.index_add_(0, seg, src)
def _pad(x, pw):
    flat = tuple(v for pair in reversed(pw) for v in pair)
    return torch.nn.functional.pad(x, flat)

kernel_name = 'standalone__mha_block_cached__decode'

def setup_inputs():

    _w = (lambda a: (lambda t: t.to(torch.bfloat16) if t.is_floating_point() else t)(torch.as_tensor(a)))
    B, Sq, D = 2, 1, 640
    H, Sk, Dh = 32, 16384, 128
    return {
        "x": _w((lambda *s: torch.randn(*s, dtype=torch.bfloat16) * 0.8)(B, Sq, D)),
        "k_cache": _w((lambda *s: torch.randn(*s, dtype=torch.bfloat16) * 0.8)(B, H, Sk, Dh)),
        "v_cache": _w((lambda *s: torch.randn(*s, dtype=torch.bfloat16) * 0.05)(B, H, Sk, Dh)),
        "wq": _w((lambda *s: torch.randn(*s, dtype=torch.bfloat16) * 0.8)(D, H * Dh) * (D ** -0.5)),
        "wo": _w((lambda *s: torch.randn(*s, dtype=torch.bfloat16) * 0.05)(H * Dh, D) * ((H * Dh) ** -0.5)),
    }

def reference(x, k_cache, v_cache, wq, wo):
    B, Sq, D = x.shape
    H, Dh = 32, 128
    q = (lambda x, *d: x.permute(*d))((x @ wq).reshape(B, Sq, H, Dh), 0, 2, 1, 3)
    scores = torch.einsum("bhqd,bhkd->bhqk", q, k_cache) * (Dh ** -0.5)
    p = _softmax(scores, axis=-1)
    o = torch.einsum("bhqk,bhkd->bhqd", p, v_cache)
    return (lambda x, *d: x.permute(*d))(o, 0, 2, 1, 3).reshape(B, Sq, H * Dh) @ wo
```

```asm
; @launch grid=(256,1,1) block=(512,1,1) lds=21504
.amdgcn_target "amdgcn-amd-amdhsa--gfx950"
.text
.globl standalone__mha_block_cached__decode_kernel
.p2align 8
.type standalone__mha_block_cached__decode_kernel,@function
standalone__mha_block_cached__decode_kernel:
    s_load_dwordx16 s[4:19], s[0:1], 0
    v_lshrrev_b32 v1, 6, v0
    s_cmp_ge_u32 s2, 256
    s_cbranch_scc1 L_end
    v_readfirstlane_b32 s3, v1
    s_lshr_b32 s25, s2, 3
    s_cmp_eq_u32 s3, 4
    s_cbranch_scc1 L_h_q
    s_cmp_lt_u32 s3, 4
    s_cbranch_scc1 L_stream
    s_getpc_b64 s[36:37]
L_pc:
    s_mul_i32 s34, s25, 3
    s_add_u32 s34, s34, s3
    s_lshl_b32 s34, s34, 7
    s_load_dword s38, s[36:37], s34
    s_addk_i32 s34, 12288
    s_min_u32 s34, s34, L_end-L_pc
    s_load_dword s38, s[36:37], s34
    s_branch L_h_other
L_stream:
    s_bfe_u32 s26, s2, 0x10006
    s_bfe_u32 s27, s2, 0x10002
    s_lshl1_add_u32 s27, s26, s27
    s_lshr_b32 s28, s2, 7
    s_and_b32 s29, s2, 3
    s_and_b32 s30, s25, 7
    s_lshl3_add_u32 s29, s29, s30
    s_lshl_b32 s30, s28, 5
    s_add_u32 s30, s30, s29
    v_and_b32 v0, 63, v0
    v_and_b32 v10, 15, v0
    v_bfe_u32 v11, v0, 4, 1
    v_lshrrev_b32 v12, 5, v0
    s_lshl2_add_u32 s37, s26, s3
    s_bfe_u32 s45, s37, 0x10000
    s_lshl_b32 s32, s45, 12
    s_bfe_u32 s45, s37, 0x10001
    s_lshl_b32 s45, s45, 15
    s_or_b32 s32, s32, s45
    s_bfe_u32 s45, s37, 0x10002
    s_lshl_b32 s45, s45, 21
    s_or_b32 s32, s32, s45
    v_lshl_add_u32 v54, v10, 4, s32
    v_lshl_add_u32 v54, v11, 9, v54
    v_lshl_add_u32 v54, v12, 14, v54
    s_mul_i32 s37, s30, 56
    s_bfe_u32 s45, s37, 0x10000
    s_lshl_b32 s53, s45, 11
    s_bfe_u32 s45, s37, 0x50001
    s_lshl_b32 s45, s45, 16
    s_or_b32 s53, s53, s45
    s_and_b32 s56, s27, 1
    s_lshl_b32 s56, s56, 10
    s_xor_b32 s57, s56, 0x2000
    s_xor_b32 s58, s56, 0x100
    s_xor_b32 s59, s56, 0x2100
    s_mov_b32 s52, 0x1f0800
    v_or_b32 v1, s53, v54
    v_add_u32 v55, s52, v54
    s_lshl_b32 s33, s30, 22
    s_mov_b32 s22, 0x400000
    s_mov_b32 s23, 0x20000
    s_waitcnt lgkmcnt(0)
    s_add_u32 s20, s6, s33
    s_addc_u32 s21, s7, 0
    buffer_load_dwordx4 v[128:131], v1, s[20:23], s56 offen nt
    buffer_load_dwordx4 v[132:135], v1, s[20:23], s57 offen nt
    buffer_load_dwordx4 v[136:139], v1, s[20:23], s58 offen nt
    buffer_load_dwordx4 v[140:143], v1, s[20:23], s59 offen nt
    v_sub_u32 v1, v1, v55
    v_bfi_b32 v1, s52, v1, v54
    buffer_load_dwordx4 v[144:147], v1, s[20:23], s56 offen nt
    s_add_u32 s34, s8, s33
    s_addc_u32 s35, s9, 0
    s_lshl2_add_u32 s37, s26, s3
    s_bfe_u32 s45, s37, 0x10000
    s_lshl_b32 s32, s45, 10
    s_bfe_u32 s45, s37, 0x10001
    s_lshl_b32 s45, s45, 12
    s_or_b32 s32, s32, s45
    s_bfe_u32 s45, s37, 0x10002
    s_lshl_b32 s45, s45, 21
    s_or_b32 s32, s32, s45
    v_lshl_add_u32 v57, v10, 4, s32
    v_lshl_add_u32 v57, v11, 8, v57
    v_lshl_add_u32 v57, v12, 15, v57
    v_mov_b32 v56, v54
    s_mov_b64 s[48:49], s[56:57]
    s_mov_b64 s[50:51], s[58:59]
    s_mov_b64 s[12:13], s[56:57]
    s_mov_b64 s[14:15], s[58:59]
    v_and_b32 v11, 1, v0
    v_lshlrev_b32 v11, 4, v11
    v_mov_b32 v12, 0xffff
    v_lshlrev_b32 v11, v11, v12
    v_bfe_u32 v12, v0, 1, 3
    v_cmp_eq_u32 s[40:41], 0, v12
    v_cmp_eq_u32 s[42:43], 1, v12
    v_cmp_eq_u32 s[44:45], 2, v12
    v_cmp_eq_u32 s[46:47], 3, v12
    v_cndmask_b32 v6, 0, v11, s[40:41]
    v_cndmask_b32 v7, 0, v11, s[42:43]
    v_cndmask_b32 v8, 0, v11, s[44:45]
    v_cndmask_b32 v9, 0, v11, s[46:47]
    s_mov_b32 s40, 0xcccccccc
    s_mov_b32 s41, s40
    s_mov_b32 s42, 0xaaaaaaaa
    s_mov_b32 s43, s42
    s_mov_b32 s44, 0x3fb8aa3b
    v_lshlrev_b32 v10, 4, v10
    v_mov_b64 v[18:19], 0
    v_mov_b64 v[20:21], 0
    v_mov_b64 v[76:77], 0
    v_mov_b64 v[78:79], 0
    s_mov_b32 s36, 0
    s_lshl_b32 s38, s3, 3
    v_mov_b32 v50, s38
    v_mov_b32 v53, 0
    v_mov_b32 v51, 0
    s_mov_b32 s39, 0
    v_lshlrev_b32 v11, 2, v0
    v_mov_b32 v12, -1
    v_mov_b32 v13, s39
    ds_write_b32 v11, v12 offset:2048
    v_mov_b32 v59, 0
    s_mov_b32 s54, -1
    s_mov_b32 s55, -1
    s_mov_b32 s89, 0
    v_mov_b32 v73, 1
    s_mov_b32 s72, -4
    s_mov_b32 s73, -4
    ds_write_b32 v53, v13 offset:512
    s_waitcnt lgkmcnt(0)
    s_barrier
    s_waitcnt vmcnt(4)
    buffer_load_dwordx4 v[148:151], v1, s[20:23], s57 offen nt
    s_waitcnt vmcnt(4)
    buffer_load_dwordx4 v[152:155], v1, s[20:23], s58 offen nt
    s_waitcnt vmcnt(4)
    buffer_load_dwordx4 v[156:159], v1, s[20:23], s59 offen nt
    v_sub_u32 v1, v1, v55
    v_bfi_b32 v1, s52, v1, v54
    s_waitcnt vmcnt(4)
    buffer_load_dwordx4 v[160:163], v1, s[20:23], s56 offen nt
    s_waitcnt vmcnt(4)
    buffer_load_dwordx4 v[164:167], v1, s[20:23], s57 offen nt
    s_waitcnt vmcnt(4)
    buffer_load_dwordx4 v[168:171], v1, s[20:23], s58 offen nt
    s_waitcnt vmcnt(4)
    buffer_load_dwordx4 v[172:175], v1, s[20:23], s59 offen nt
    v_sub_u32 v1, v1, v55
    v_bfi_b32 v1, s52, v1, v54
    s_waitcnt vmcnt(4)
    buffer_load_dwordx4 v[176:179], v1, s[20:23], s56 offen nt
    s_waitcnt vmcnt(4)
    buffer_load_dwordx4 v[180:183], v1, s[20:23], s57 offen nt
    s_waitcnt vmcnt(4)
    buffer_load_dwordx4 v[184:187], v1, s[20:23], s58 offen nt
    s_waitcnt vmcnt(4)
    buffer_load_dwordx4 v[188:191], v1, s[20:23], s59 offen nt
    v_sub_u32 v1, v1, v55
    v_bfi_b32 v1, s52, v1, v54
    s_waitcnt vmcnt(4)
    buffer_load_dwordx4 v[192:195], v1, s[20:23], s56 offen nt
    s_waitcnt vmcnt(4)
    buffer_load_dwordx4 v[196:199], v1, s[20:23], s57 offen nt
    s_waitcnt vmcnt(4)
    buffer_load_dwordx4 v[200:203], v1, s[20:23], s58 offen nt
    s_waitcnt vmcnt(4)
    buffer_load_dwordx4 v[204:207], v1, s[20:23], s59 offen nt
    v_sub_u32 v1, v1, v55
    v_bfi_b32 v1, s52, v1, v54
    s_waitcnt vmcnt(4)
    buffer_load_dwordx4 v[208:211], v1, s[20:23], s56 offen nt
    s_waitcnt vmcnt(4)
    buffer_load_dwordx4 v[212:215], v1, s[20:23], s57 offen nt
    s_waitcnt vmcnt(4)
    buffer_load_dwordx4 v[216:219], v1, s[20:23], s58 offen nt
    s_waitcnt vmcnt(4)
    buffer_load_dwordx4 v[220:223], v1, s[20:23], s59 offen nt
    v_sub_u32 v1, v1, v55
    v_bfi_b32 v1, s52, v1, v54
    s_waitcnt vmcnt(4)
    buffer_load_dwordx4 v[224:227], v1, s[20:23], s56 offen nt
    s_waitcnt vmcnt(4)
    buffer_load_dwordx4 v[228:231], v1, s[20:23], s57 offen nt
    s_waitcnt vmcnt(4)
    buffer_load_dwordx4 v[232:235], v1, s[20:23], s58 offen nt
    ds_read_b32 v52, v53 offset:2176
    ds_read_b128 v[2:5], v10 offset:0
    s_waitcnt lgkmcnt(0)
    v_cmp_ne_u32 vcc, 0, v52
    s_nop 0
    s_cbranch_vccz L_kloop
    s_waitcnt vmcnt(4)
    buffer_load_dwordx4 v[236:239], v1, s[20:23], s59 offen nt
    v_sub_u32 v1, v1, v55
    v_bfi_b32 v1, s52, v1, v54
    s_waitcnt vmcnt(4)
    buffer_load_dwordx4 v[240:243], v1, s[20:23], s56 offen nt
    s_waitcnt vmcnt(4)
    buffer_load_dwordx4 v[244:247], v1, s[20:23], s57 offen nt
    s_waitcnt vmcnt(4)
    buffer_load_dwordx4 v[248:251], v1, s[20:23], s58 offen nt
    s_mov_b32 s45, 16777216
L_waitq:
    ds_read_b32 v52, v53 offset:2176
    ds_read_b128 v[2:5], v10 offset:0
    s_sub_u32 s45, s45, 1
    s_cbranch_scc1 L_gotq
    s_waitcnt lgkmcnt(0)
    v_cmp_ne_u32 vcc, 0, v52
    s_nop 0
    s_cbranch_vccnz L_waitq
L_gotq:
    v_add_u32 v51, 1, v51
    s_mov_b64 exec, 1
    ds_write_b32 v50, v51 offset:2112
    s_mov_b64 exec, -1
    v_dot2_f32_bf16 v40, v128, v2, 0
    v_dot2_f32_bf16 v40, v129, v3, v40
    v_dot2_f32_bf16 v40, v130, v4, v40
    v_dot2_f32_bf16 v40, v131, v5, v40
    v_dot2_f32_bf16 v41, v132, v2, 0
    s_nop 1
    v_add_f32_dpp v42, v40, v40 row_ror:8 row_mask:0xf bank_mask:0x3
    v_dot2_f32_bf16 v41, v133, v3, v41
    v_dot2_f32_bf16 v41, v134, v4, v41
    v_dot2_f32_bf16 v41, v135, v5, v41
    v_dot2_f32_bf16 v40, v136, v2, 0
    s_nop 1
    v_add_f32_dpp v42, v41, v41 row_ror:8 row_mask:0xf bank_mask:0xc
    v_dot2_f32_bf16 v40, v137, v3, v40
    v_dot2_f32_bf16 v40, v138, v4, v40
    v_add_f32_dpp v44, v42, v42 row_shl:4 row_mask:0xf bank_mask:0x5
    v_dot2_f32_bf16 v40, v139, v5, v40
    v_dot2_f32_bf16 v41, v140, v2, 0
    s_nop 1
    v_add_f32_dpp v43, v40, v40 row_ror:8 row_mask:0xf bank_mask:0x3
    v_dot2_f32_bf16 v41, v141, v3, v41
    v_dot2_f32_bf16 v41, v142, v4, v41
    v_dot2_f32_bf16 v41, v143, v5, v41
    s_mov_b32 s73, 0
    s_branch L_kenter
L_getmode:
    s_mov_b32 s45, 16777216
L_waitmode:
    ds_read_b32 v58, v53 offset:2180
    s_sub_u32 s45, s45, 1
    s_cbranch_scc1 L_getmode_back
    s_waitcnt lgkmcnt(0)
    v_readfirstlane_b32 s64, v58
    s_nop 0
    s_cmp_lt_i32 s64, 0
    s_cbranch_scc1 L_waitmode
    s_bitcmp1_b32 s64, 0
    s_cbranch_scc0 L_getmode_back
    s_and_b32 s45, s64, 0x2000
    s_lshl_b32 s65, s64, 12
    s_and_b32 s65, s65, 0x2000
    s_cselect_b32 s54, 1, -1
    s_xor_b32 s64, s45, s65
    s_mov_b32 s55, 0
    s_mov_b32 s48, s64
    s_xor_b32 s49, s45, 0x4000
    s_xor_b32 s50, s64, 0x200
    s_xor_b32 s51, s45, 0x4200
    s_mov_b32 s12, s45
    s_xor_b32 s13, s64, 0x4000
    s_xor_b32 s14, s45, 0x200
    s_xor_b32 s15, s45, 0x4200
    s_mov_b64 s[60:61], s[48:49]
    s_mov_b64 s[62:63], s[50:51]
    s_mov_b64 s[4:5], s[12:13]
    s_mov_b64 s[6:7], s[14:15]
    s_xor_b32 s63, s63, s65
    s_xor_b32 s7, s7, s65
    v_mov_b32 v54, v57
    v_add_u32 v55, s52, v57
    v_bfi_b32 v1, s52, v1, v57
    v_mov_b32 v59, 4
    s_branch L_getmode_back
L_tov:
    s_mov_b64 s[20:21], s[34:35]
    s_mov_b64 s[48:49], s[56:57]
    s_mov_b64 s[50:51], s[58:59]
    s_mov_b64 s[12:13], s[56:57]
    s_mov_b64 s[14:15], s[58:59]
    v_mov_b32 v54, v56
    v_add_u32 v55, s52, v56
    v_bfi_b32 v1, s52, v1, v56
    v_mov_b32 v59, 0
    s_branch L_tov_back
.p2align 6
L_kloop:
    v_add_u32 v51, 1, v51
    s_mov_b64 exec, 1
    ds_write_b32 v50, v51 offset:2112
    s_mov_b64 exec, -1
    s_sub_u32 s72, s72, s73
    s_add_u32 s73, s73, 4
    s_cmp_lt_i32 s72, 0
    s_cselect_b32 s74, 1, 0
    s_or_b32 s39, s39, s74
    s_cmp_gt_i32 s72, 1
    s_cselect_b32 s74, 256, 0
    s_or_b32 s39, s39, s74
    s_bitcmp1_b32 s39, 0
    s_cselect_b64 vcc, -1, 0
    s_bitcmp1_b32 s39, 8
    s_cbranch_scc1 L_hi318
    s_cbranch_vccz L_mid318
    s_waitcnt vmcnt(3)
L_mid318:
    s_waitcnt vmcnt(4)
L_hi318:
    s_waitcnt vmcnt(5)
    buffer_load_dwordx4 v[236:239], v1, s[20:23], s51 offen nt
    v_sub_u32 v1, v1, v55
    v_bfi_b32 v1, s52, v1, v54
    v_dot2_f32_bf16 v40, v128, v2, 0
    v_dot2_f32_bf16 v40, v129, v3, v40
    v_dot2_f32_bf16 v40, v130, v4, v40
    v_dot2_f32_bf16 v40, v131, v5, v40
    s_cbranch_scc1 L_hi332
    s_cbranch_vccz L_mid332
    s_waitcnt vmcnt(3)
L_mid332:
    s_waitcnt vmcnt(4)
L_hi332:
    s_waitcnt vmcnt(5)
    buffer_load_dwordx4 v[240:243], v1, s[20:23], s12 offen nt
    v_dot2_f32_bf16 v41, v132, v2, 0
    v_add_f32_dpp v42, v40, v40 row_ror:8 row_mask:0xf bank_mask:0x3
    v_dot2_f32_bf16 v41, v133, v3, v41
    v_dot2_f32_bf16 v41, v134, v4, v41
    v_dot2_f32_bf16 v41, v135, v5, v41
    s_cbranch_scc1 L_hi345
    s_cbranch_vccz L_mid345
    s_waitcnt vmcnt(3)
L_mid345:
    s_waitcnt vmcnt(4)
L_hi345:
    s_waitcnt vmcnt(5)
    buffer_load_dwordx4 v[244:247], v1, s[20:23], s13 offen nt
    v_dot2_f32_bf16 v40, v136, v2, 0
    v_add_f32_dpp v42, v41, v41 row_ror:8 row_mask:0xf bank_mask:0xc
    v_dot2_f32_bf16 v40, v137, v3, v40
    v_dot2_f32_bf16 v40, v138, v4, v40
    v_add_f32_dpp v44, v42, v42 row_shl:4 row_mask:0xf bank_mask:0x5
    v_dot2_f32_bf16 v40, v139, v5, v40
    s_cbranch_scc1 L_hi359
    s_cbranch_vccz L_mid359
    s_waitcnt vmcnt(3)
L_mid359:
    s_waitcnt vmcnt(4)
L_hi359:
    s_waitcnt vmcnt(5)
    buffer_load_dwordx4 v[248:251], v1, s[20:23], s14 offen nt
    v_dot2_f32_bf16 v41, v140, v2, 0
    v_add_f32_dpp v43, v40, v40 row_ror:8 row_mask:0xf bank_mask:0x3
    v_dot2_f32_bf16 v41, v141, v3, v41
    v_dot2_f32_bf16 v41, v142, v4, v41
    v_dot2_f32_bf16 v41, v143, v5, v41
L_kenter:
    s_bitcmp1_b32 s39, 1
    s_cselect_b64 vcc, -1, 0
    s_bitcmp1_b32 s39, 9
    s_cbranch_scc1 L_hi376
    s_cbranch_vccz L_mid376
    s_waitcnt vmcnt(3)
L_mid376:
    s_waitcnt vmcnt(4)
L_hi376:
    s_waitcnt vmcnt(5)
    buffer_load_dwordx4 v[252:255], v1, s[20:23], s15 offen nt
    v_sub_u32 v1, v1, v55
    v_bfi_b32 v1, s52, v1, v54
    s_cmp_eq_u32 s36, 7
    s_cbranch_scc1 L_tov
L_tov_back:
    s_bitcmp1_b32 s39, 9
    v_dot2_f32_bf16 v40, v144, v2, 0
    v_add_f32_dpp v43, v41, v41 row_ror:8 row_mask:0xf bank_mask:0xc
    v_dot2_f32_bf16 v40, v145, v3, v40
    v_dot2_f32_bf16 v40, v146, v4, v40
    v_add_f32_dpp v44, v43, v43 row_shr:4 row_mask:0xf bank_mask:0xa
    v_dot2_f32_bf16 v40, v147, v5, v40
    s_nop 0
    v_add_f32_dpp v48, v44, v44 quad_perm:[2,3,0,1] row_mask:0xf bank_mask:0xf
    s_cbranch_scc1 L_hi397
    s_cbranch_vccz L_mid397
    s_waitcnt vmcnt(3)
L_mid397:
    s_waitcnt vmcnt(4)
L_hi397:
    s_waitcnt vmcnt(5)
    buffer_load_dwordx4 v[128:131], v1, s[20:23], s48 offen nt
    v_dot2_f32_bf16 v41, v148, v2, 0
    v_add_f32_dpp v42, v40, v40 row_ror:8 row_mask:0xf bank_mask:0x3
    v_dot2_f32_bf16 v41, v149, v3, v41
    v_dot2_f32_bf16 v41, v150, v4, v41
    v_dot2_f32_bf16 v41, v151, v5, v41
    ds_read_b32 v52, v59 offset:512
    s_mov_b64 exec, 1
    ds_add_rtn_u32 v72, v53, v73 offset:2188
    s_mov_b64 exec, -1
    s_cbranch_scc1 L_hi414
    s_cbranch_vccz L_mid414
    s_waitcnt vmcnt(3)
L_mid414:
    s_waitcnt vmcnt(4)
L_hi414:
    s_waitcnt vmcnt(5)
    buffer_load_dwordx4 v[132:135], v1, s[20:23], s49 offen nt
    v_dot2_f32_bf16 v40, v152, v2, 0
    v_add_f32_dpp v42, v41, v41 row_ror:8 row_mask:0xf bank_mask:0xc
    v_dot2_f32_bf16 v40, v153, v3, v40
    v_dot2_f32_bf16 v40, v154, v4, v40
    v_add_f32_dpp v45, v42, v42 row_shl:4 row_mask:0xf bank_mask:0x5
    v_dot2_f32_bf16 v40, v155, v5, v40
    s_waitcnt lgkmcnt(0)
    v_readfirstlane_b32 s72, v72
    v_readfirstlane_b32 s39, v52
    s_cbranch_scc1 L_hi431
    s_cbranch_vccz L_mid431
    s_waitcnt vmcnt(3)
L_mid431:
    s_waitcnt vmcnt(4)
L_hi431:
    s_waitcnt vmcnt(5)
    buffer_load_dwordx4 v[136:139], v1, s[20:23], s50 offen nt
    v_dot2_f32_bf16 v41, v156, v2, 0
    v_add_f32_dpp v43, v40, v40 row_ror:8 row_mask:0xf bank_mask:0x3
    v_dot2_f32_bf16 v41, v157, v3, v41
    v_dot2_f32_bf16 v41, v158, v4, v41
    v_dot2_f32_bf16 v41, v159, v5, v41
    s_sub_u32 s72, s72, s73
    s_add_u32 s73, s73, 4
    s_cmp_lt_i32 s72, 0
    s_cselect_b32 s74, 4, 0
    s_or_b32 s39, s39, s74
    s_cmp_gt_i32 s72, 1
    s_cselect_b32 s74, 1024, 0
    s_or_b32 s39, s39, s74
    s_bitcmp1_b32 s39, 2
    s_cselect_b64 vcc, -1, 0
    s_bitcmp1_b32 s39, 10
    s_cbranch_scc1 L_hi455
    s_cbranch_vccz L_mid455
    s_waitcnt vmcnt(3)
L_mid455:
    s_waitcnt vmcnt(4)
L_hi455:
    s_waitcnt vmcnt(5)
    buffer_load_dwordx4 v[140:143], v1, s[20:23], s51 offen nt
    v_sub_u32 v1, v1, v55
    v_bfi_b32 v1, s52, v1, v54
    v_dot2_f32_bf16 v40, v160, v2, 0
    v_add_f32_dpp v43, v41, v41 row_ror:8 row_mask:0xf bank_mask:0xc
    v_dot2_f32_bf16 v40, v161, v3, v40
    v_dot2_f32_bf16 v40, v162, v4, v40
    v_add_f32_dpp v45, v43, v43 row_shr:4 row_mask:0xf bank_mask:0xa
    v_dot2_f32_bf16 v40, v163, v5, v40
    s_nop 0
    v_add_f32_dpp v49, v45, v45 quad_perm:[2,3,0,1] row_mask:0xf bank_mask:0xf
    v_cndmask_b32 v46, v48, v49, s[40:41]
    s_nop 1
    v_add_f32_dpp v46, v46, v46 quad_perm:[1,0,3,2] row_mask:0xf bank_mask:0xf
    s_cbranch_scc1 L_hi474
    s_cbranch_vccz L_mid474
    s_waitcnt vmcnt(3)
L_mid474:
    s_waitcnt vmcnt(4)
L_hi474:
    s_waitcnt vmcnt(5)
    buffer_load_dwordx4 v[144:147], v1, s[20:23], s12 offen nt
    v_dot2_f32_bf16 v41, v164, v2, 0
    v_add_f32_dpp v42, v40, v40 row_ror:8 row_mask:0xf bank_mask:0x3
    v_dot2_f32_bf16 v41, v165, v3, v41
    v_dot2_f32_bf16 v41, v166, v4, v41
    v_dot2_f32_bf16 v41, v167, v5, v41
    s_cbranch_scc1 L_hi487
    s_cbranch_vccz L_mid487
    s_waitcnt vmcnt(3)
L_mid487:
    s_waitcnt vmcnt(4)
L_hi487:
    s_waitcnt vmcnt(5)
    buffer_load_dwordx4 v[148:151], v1, s[20:23], s13 offen nt
    v_dot2_f32_bf16 v40, v168, v2, 0
    v_add_f32_dpp v42, v41, v41 row_ror:8 row_mask:0xf bank_mask:0xc
    v_dot2_f32_bf16 v40, v169, v3, v40
    v_dot2_f32_bf16 v40, v170, v4, v40
    v_add_f32_dpp v44, v42, v42 row_shl:4 row_mask:0xf bank_mask:0x5
    v_dot2_f32_bf16 v40, v171, v5, v40
    s_cbranch_scc1 L_hi501
    s_cbranch_vccz L_mid501
    s_waitcnt vmcnt(3)
L_mid501:
    s_waitcnt vmcnt(4)
L_hi501:
    s_waitcnt vmcnt(5)
    buffer_load_dwordx4 v[152:155], v1, s[20:23], s14 offen nt
    v_dot2_f32_bf16 v41, v172, v2, 0
    v_add_f32_dpp v43, v40, v40 row_ror:8 row_mask:0xf bank_mask:0x3
    v_dot2_f32_bf16 v41, v173, v3, v41
    v_dot2_f32_bf16 v41, v174, v4, v41
    v_dot2_f32_bf16 v41, v175, v5, v41
    s_bitcmp1_b32 s39, 3
    s_cselect_b64 vcc, -1, 0
    s_bitcmp1_b32 s39, 11
    s_cbranch_scc1 L_hi517
    s_cbranch_vccz L_mid517
    s_waitcnt vmcnt(3)
L_mid517:
    s_waitcnt vmcnt(4)
L_hi517:
    s_waitcnt vmcnt(5)
    buffer_load_dwordx4 v[156:159], v1, s[20:23], s15 offen nt
    v_sub_u32 v1, v1, v55
    v_bfi_b32 v1, s52, v1, v54
    v_dot2_f32_bf16 v40, v176, v2, 0
    v_add_f32_dpp v43, v41, v41 row_ror:8 row_mask:0xf bank_mask:0xc
    v_dot2_f32_bf16 v40, v177, v3, v40
    v_dot2_f32_bf16 v40, v178, v4, v40
    v_add_f32_dpp v44, v43, v43 row_shr:4 row_mask:0xf bank_mask:0xa
    v_dot2_f32_bf16 v40, v179, v5, v40
    s_nop 0
    v_add_f32_dpp v48, v44, v44 quad_perm:[2,3,0,1] row_mask:0xf bank_mask:0xf
    s_cbranch_scc1 L_hi534
    s_cbranch_vccz L_mid534
    s_waitcnt vmcnt(3)
L_mid534:
    s_waitcnt vmcnt(4)
L_hi534:
    s_waitcnt vmcnt(5)
    buffer_load_dwordx4 v[160:163], v1, s[20:23], s48 offen nt
    v_dot2_f32_bf16 v41, v180, v2, 0
    v_add_f32_dpp v42, v40, v40 row_ror:8 row_mask:0xf bank_mask:0x3
    v_dot2_f32_bf16 v41, v181, v3, v41
    v_dot2_f32_bf16 v41, v182, v4, v41
    v_dot2_f32_bf16 v41, v183, v5, v41
    ds_read_b32 v52, v59 offset:512
    s_mov_b64 exec, 1
    ds_add_rtn_u32 v72, v53, v73 offset:2188
    s_mov_b64 exec, -1
    s_cbranch_scc1 L_hi551
    s_cbranch_vccz L_mid551
    s_waitcnt vmcnt(3)
L_mid551:
    s_waitcnt vmcnt(4)
L_hi551:
    s_waitcnt vmcnt(5)
    buffer_load_dwordx4 v[164:167], v1, s[20:23], s49 offen nt
    v_dot2_f32_bf16 v40, v184, v2, 0
    v_add_f32_dpp v42, v41, v41 row_ror:8 row_mask:0xf bank_mask:0xc
    v_dot2_f32_bf16 v40, v185, v3, v40
    v_dot2_f32_bf16 v40, v186, v4, v40
    v_add_f32_dpp v45, v42, v42 row_shl:4 row_mask:0xf bank_mask:0x5
    v_dot2_f32_bf16 v40, v187, v5, v40
    s_waitcnt lgkmcnt(0)
    v_readfirstlane_b32 s72, v72
    v_readfirstlane_b32 s39, v52
    s_cbranch_scc1 L_hi568
    s_cbranch_vccz L_mid568
    s_waitcnt vmcnt(3)
L_mid568:
    s_waitcnt vmcnt(4)
L_hi568:
    s_waitcnt vmcnt(5)
    buffer_load_dwordx4 v[168:171], v1, s[20:23], s50 offen nt
    v_dot2_f32_bf16 v41, v188, v2, 0
    v_add_f32_dpp v43, v40, v40 row_ror:8 row_mask:0xf bank_mask:0x3
    v_dot2_f32_bf16 v41, v189, v3, v41
    v_dot2_f32_bf16 v41, v190, v4, v41
    v_dot2_f32_bf16 v41, v191, v5, v41
    s_sub_u32 s72, s72, s73
    s_add_u32 s73, s73, 4
    s_cmp_lt_i32 s72, 0
    s_cselect_b32 s74, 16, 0
    s_or_b32 s39, s39, s74
    s_cmp_gt_i32 s72, 1
    s_cselect_b32 s74, 4096, 0
    s_or_b32 s39, s39, s74
    s_bitcmp1_b32 s39, 4
    s_cselect_b64 vcc, -1, 0
    s_bitcmp1_b32 s39, 12
    s_cbranch_scc1 L_hi592
    s_cbranch_vccz L_mid592
    s_waitcnt vmcnt(3)
L_mid592:
    s_waitcnt vmcnt(4)
L_hi592:
    s_waitcnt vmcnt(5)
    buffer_load_dwordx4 v[172:175], v1, s[20:23], s51 offen nt
    v_sub_u32 v1, v1, v55
    v_bfi_b32 v1, s52, v1, v54
    v_dot2_f32_bf16 v40, v192, v2, 0
    v_add_f32_dpp v43, v41, v41 row_ror:8 row_mask:0xf bank_mask:0xc
    v_dot2_f32_bf16 v40, v193, v3, v40
    v_dot2_f32_bf16 v40, v194, v4, v40
    v_add_f32_dpp v45, v43, v43 row_shr:4 row_mask:0xf bank_mask:0xa
    v_dot2_f32_bf16 v40, v195, v5, v40
    s_nop 0
    v_add_f32_dpp v49, v45, v45 quad_perm:[2,3,0,1] row_mask:0xf bank_mask:0xf
    v_cndmask_b32 v47, v48, v49, s[40:41]
    s_nop 1
    v_add_f32_dpp v47, v47, v47 quad_perm:[1,0,3,2] row_mask:0xf bank_mask:0xf
    v_cndmask_b32 v38, v46, v47, s[42:43]
    s_cbranch_scc1 L_hi612
    s_cbranch_vccz L_mid612
    s_waitcnt vmcnt(3)
L_mid612:
    s_waitcnt vmcnt(4)
L_hi612:
    s_waitcnt vmcnt(5)
    buffer_load_dwordx4 v[176:179], v1, s[20:23], s12 offen nt
    v_dot2_f32_bf16 v41, v196, v2, 0
    v_add_f32_dpp v42, v40, v40 row_ror:8 row_mask:0xf bank_mask:0x3
    v_dot2_f32_bf16 v41, v197, v3, v41
    v_dot2_f32_bf16 v41, v198, v4, v41
    v_dot2_f32_bf16 v41, v199, v5, v41
    s_cbranch_scc1 L_hi625
    s_cbranch_vccz L_mid625
    s_waitcnt vmcnt(3)
L_mid625:
    s_waitcnt vmcnt(4)
L_hi625:
    s_waitcnt vmcnt(5)
    buffer_load_dwordx4 v[180:183], v1, s[20:23], s13 offen nt
    v_dot2_f32_bf16 v40, v200, v2, 0
    v_add_f32_dpp v42, v41, v41 row_ror:8 row_mask:0xf bank_mask:0xc
    v_dot2_f32_bf16 v40, v201, v3, v40
    v_dot2_f32_bf16 v40, v202, v4, v40
    v_add_f32_dpp v44, v42, v42 row_shl:4 row_mask:0xf bank_mask:0x5
    v_dot2_f32_bf16 v40, v203, v5, v40
    s_cbranch_scc1 L_hi639
    s_cbranch_vccz L_mid639
    s_waitcnt vmcnt(3)
L_mid639:
    s_waitcnt vmcnt(4)
L_hi639:
    s_waitcnt vmcnt(5)
    buffer_load_dwordx4 v[184:187], v1, s[20:23], s14 offen nt
    v_dot2_f32_bf16 v41, v204, v2, 0
    v_add_f32_dpp v43, v40, v40 row_ror:8 row_mask:0xf bank_mask:0x3
    v_dot2_f32_bf16 v41, v205, v3, v41
    v_dot2_f32_bf16 v41, v206, v4, v41
    v_dot2_f32_bf16 v41, v207, v5, v41
    s_bitcmp1_b32 s39, 5
    s_cselect_b64 vcc, -1, 0
    s_bitcmp1_b32 s39, 13
    s_cbranch_scc1 L_hi655
    s_cbranch_vccz L_mid655
    s_waitcnt vmcnt(3)
L_mid655:
    s_waitcnt vmcnt(4)
L_hi655:
    s_waitcnt vmcnt(5)
    buffer_load_dwordx4 v[188:191], v1, s[20:23], s15 offen nt
    v_sub_u32 v1, v1, v55
    v_bfi_b32 v1, s52, v1, v54
    s_cmp_eq_u32 s36, 0
    s_cbranch_scc1 L_getmode
L_getmode_back:
    s_bitcmp1_b32 s39, 13
    v_dot2_f32_bf16 v40, v208, v2, 0
    v_add_f32_dpp v43, v41, v41 row_ror:8 row_mask:0xf bank_mask:0xc
    v_dot2_f32_bf16 v40, v209, v3, v40
    v_dot2_f32_bf16 v40, v210, v4, v40
    v_add_f32_dpp v44, v43, v43 row_shr:4 row_mask:0xf bank_mask:0xa
    v_dot2_f32_bf16 v40, v211, v5, v40
    s_nop 0
    v_add_f32_dpp v48, v44, v44 quad_perm:[2,3,0,1] row_mask:0xf bank_mask:0xf
    s_cbranch_scc1 L_hi676
    s_cbranch_vccz L_mid676
    s_waitcnt vmcnt(3)
L_mid676:
    s_waitcnt vmcnt(4)
L_hi676:
    s_waitcnt vmcnt(5)
    buffer_load_dwordx4 v[192:195], v1, s[20:23], s48 offen nt
    v_dot2_f32_bf16 v41, v212, v2, 0
    v_add_f32_dpp v42, v40, v40 row_ror:8 row_mask:0xf bank_mask:0x3
    v_dot2_f32_bf16 v41, v213, v3, v41
    v_dot2_f32_bf16 v41, v214, v4, v41
    v_dot2_f32_bf16 v41, v215, v5, v41
    ds_read_b32 v52, v59 offset:512
    s_mov_b64 exec, 1
    ds_add_rtn_u32 v72, v53, v73 offset:2188
    s_mov_b64 exec, -1
    s_cbranch_scc1 L_hi693
    s_cbranch_vccz L_mid693
    s_waitcnt vmcnt(3)
L_mid693:
    s_waitcnt vmcnt(4)
L_hi693:
    s_waitcnt vmcnt(5)
    buffer_load_dwordx4 v[196:199], v1, s[20:23], s49 offen nt
    v_dot2_f32_bf16 v40, v216, v2, 0
    v_add_f32_dpp v42, v41, v41 row_ror:8 row_mask:0xf bank_mask:0xc
    v_dot2_f32_bf16 v40, v217, v3, v40
    v_dot2_f32_bf16 v40, v218, v4, v40
    v_add_f32_dpp v45, v42, v42 row_shl:4 row_mask:0xf bank_mask:0x5
    v_dot2_f32_bf16 v40, v219, v5, v40
    s_waitcnt lgkmcnt(0)
    v_readfirstlane_b32 s72, v72
    v_readfirstlane_b32 s39, v52
    s_cbranch_scc1 L_hi710
    s_cbranch_vccz L_mid710
    s_waitcnt vmcnt(3)
L_mid710:
    s_waitcnt vmcnt(4)
L_hi710:
    s_waitcnt vmcnt(5)
    buffer_load_dwordx4 v[200:203], v1, s[20:23], s50 offen nt
    v_dot2_f32_bf16 v41, v220, v2, 0
    v_add_f32_dpp v43, v40, v40 row_ror:8 row_mask:0xf bank_mask:0x3
    v_dot2_f32_bf16 v41, v221, v3, v41
    v_dot2_f32_bf16 v41, v222, v4, v41
    v_dot2_f32_bf16 v41, v223, v5, v41
    s_sub_u32 s72, s72, s73
    s_add_u32 s73, s73, 4
    s_cmp_lt_i32 s72, 0
    s_cselect_b32 s74, 64, 0
    s_or_b32 s39, s39, s74
    s_cmp_gt_i32 s72, 1
    s_cselect_b32 s74, 16384, 0
    s_or_b32 s39, s39, s74
    s_bitcmp1_b32 s39, 6
    s_cselect_b64 vcc, -1, 0
    s_bitcmp1_b32 s39, 14
    s_cbranch_scc1 L_hi734
    s_cbranch_vccz L_mid734
    s_waitcnt vmcnt(3)
L_mid734:
    s_waitcnt vmcnt(4)
L_hi734:
    s_waitcnt vmcnt(5)
    buffer_load_dwordx4 v[204:207], v1, s[20:23], s51 offen nt
    v_sub_u32 v1, v1, v55
    v_bfi_b32 v1, s52, v1, v54
    v_dot2_f32_bf16 v40, v224, v2, 0
    v_add_f32_dpp v43, v41, v41 row_ror:8 row_mask:0xf bank_mask:0xc
    v_dot2_f32_bf16 v40, v225, v3, v40
    v_dot2_f32_bf16 v40, v226, v4, v40
    v_add_f32_dpp v45, v43, v43 row_shr:4 row_mask:0xf bank_mask:0xa
    v_dot2_f32_bf16 v40, v227, v5, v40
    s_nop 0
    v_add_f32_dpp v49, v45, v45 quad_perm:[2,3,0,1] row_mask:0xf bank_mask:0xf
    v_cndmask_b32 v46, v48, v49, s[40:41]
    s_nop 1
    v_add_f32_dpp v46, v46, v46 quad_perm:[1,0,3,2] row_mask:0xf bank_mask:0xf
    s_cbranch_scc1 L_hi753
    s_cbranch_vccz L_mid753
    s_waitcnt vmcnt(3)
L_mid753:
    s_waitcnt vmcnt(4)
L_hi753:
    s_waitcnt vmcnt(5)
    buffer_load_dwordx4 v[208:211], v1, s[20:23], s12 offen nt
    v_dot2_f32_bf16 v41, v228, v2, 0
    v_add_f32_dpp v42, v40, v40 row_ror:8 row_mask:0xf bank_mask:0x3
    v_dot2_f32_bf16 v41, v229, v3, v41
    v_dot2_f32_bf16 v41, v230, v4, v41
    v_dot2_f32_bf16 v41, v231, v5, v41
    s_cbranch_scc1 L_hi766
    s_cbranch_vccz L_mid766
    s_waitcnt vmcnt(3)
L_mid766:
    s_waitcnt vmcnt(4)
L_hi766:
    s_waitcnt vmcnt(5)
    buffer_load_dwordx4 v[212:215], v1, s[20:23], s13 offen nt
    v_dot2_f32_bf16 v40, v232, v2, 0
    v_add_f32_dpp v42, v41, v41 row_ror:8 row_mask:0xf bank_mask:0xc
    v_dot2_f32_bf16 v40, v233, v3, v40
    v_dot2_f32_bf16 v40, v234, v4, v40
    v_add_f32_dpp v44, v42, v42 row_shl:4 row_mask:0xf bank_mask:0x5
    v_dot2_f32_bf16 v40, v235, v5, v40
    s_cbranch_scc1 L_hi780
    s_cbranch_vccz L_mid780
    s_waitcnt vmcnt(3)
L_mid780:
    s_waitcnt vmcnt(4)
L_hi780:
    s_waitcnt vmcnt(5)
    buffer_load_dwordx4 v[216:219], v1, s[20:23], s14 offen nt
    v_dot2_f32_bf16 v41, v236, v2, 0
    v_add_f32_dpp v43, v40, v40 row_ror:8 row_mask:0xf bank_mask:0x3
    v_dot2_f32_bf16 v41, v237, v3, v41
    v_dot2_f32_bf16 v41, v238, v4, v41
    v_dot2_f32_bf16 v41, v239, v5, v41
    s_bitcmp1_b32 s39, 7
    s_cselect_b64 vcc, -1, 0
    s_bitcmp1_b32 s39, 15
    s_cbranch_scc1 L_hi796
    s_cbranch_vccz L_mid796
    s_waitcnt vmcnt(3)
L_mid796:
    s_waitcnt vmcnt(4)
L_hi796:
    s_waitcnt vmcnt(7)
    buffer_load_dwordx4 v[220:223], v1, s[20:23], s15 offen nt
    v_sub_u32 v1, v1, v55
    v_bfi_b32 v1, s52, v1, v54
    v_dot2_f32_bf16 v40, v240, v2, 0
    v_add_f32_dpp v43, v41, v41 row_ror:8 row_mask:0xf bank_mask:0xc
    v_dot2_f32_bf16 v40, v241, v3, v40
    v_dot2_f32_bf16 v40, v242, v4, v40
    v_add_f32_dpp v44, v43, v43 row_shr:4 row_mask:0xf bank_mask:0xa
    v_dot2_f32_bf16 v40, v243, v5, v40
    s_nop 0
    v_add_f32_dpp v48, v44, v44 quad_perm:[2,3,0,1] row_mask:0xf bank_mask:0xf
    s_cbranch_scc1 L_hi813
    s_cbranch_vccz L_mid813
    s_waitcnt vmcnt(3)
L_mid813:
    s_waitcnt vmcnt(4)
L_hi813:
    s_waitcnt vmcnt(7)
    buffer_load_dwordx4 v[224:227], v1, s[20:23], s48 offen nt
    v_dot2_f32_bf16 v41, v244, v2, 0
    v_add_f32_dpp v42, v40, v40 row_ror:8 row_mask:0xf bank_mask:0x3
    v_dot2_f32_bf16 v41, v245, v3, v41
    v_dot2_f32_bf16 v41, v246, v4, v41
    v_dot2_f32_bf16 v41, v247, v5, v41
    ds_read_b32 v52, v59 offset:512
    s_mov_b64 exec, 1
    ds_add_rtn_u32 v72, v53, v73 offset:2188
    s_mov_b64 exec, -1
    s_cbranch_scc1 L_hi830
    s_cbranch_vccz L_mid830
    s_waitcnt vmcnt(3)
L_mid830:
    s_waitcnt vmcnt(4)
L_hi830:
    s_waitcnt vmcnt(7)
    buffer_load_dwordx4 v[228:231], v1, s[20:23], s49 offen nt
    v_dot2_f32_bf16 v40, v248, v2, 0
    v_add_f32_dpp v42, v41, v41 row_ror:8 row_mask:0xf bank_mask:0xc
    v_dot2_f32_bf16 v40, v249, v3, v40
    v_dot2_f32_bf16 v40, v250, v4, v40
    v_add_f32_dpp v45, v42, v42 row_shl:4 row_mask:0xf bank_mask:0x5
    v_dot2_f32_bf16 v40, v251, v5, v40
    s_waitcnt lgkmcnt(0)
    v_readfirstlane_b32 s72, v72
    v_readfirstlane_b32 s39, v52
    s_cbranch_scc1 L_hi847
    s_cbranch_vccz L_mid847
    s_waitcnt vmcnt(3)
L_mid847:
    s_waitcnt vmcnt(4)
L_hi847:
    s_waitcnt vmcnt(7)
    buffer_load_dwordx4 v[232:235], v1, s[20:23], s50 offen nt
    v_dot2_f32_bf16 v41, v252, v2, 0
    v_add_f32_dpp v43, v40, v40 row_ror:8 row_mask:0xf bank_mask:0x3
    v_dot2_f32_bf16 v41, v253, v3, v41
    v_dot2_f32_bf16 v41, v254, v4, v41
    v_dot2_f32_bf16 v41, v255, v5, v41
    s_nop 2
    v_add_f32_dpp v43, v41, v41 row_ror:8 row_mask:0xf bank_mask:0xc
    s_nop 1
    v_add_f32_dpp v45, v43, v43 row_shr:4 row_mask:0xf bank_mask:0xa
    s_nop 1
    v_add_f32_dpp v49, v45, v45 quad_perm:[2,3,0,1] row_mask:0xf bank_mask:0xf
    v_cndmask_b32 v47, v48, v49, s[40:41]
    s_nop 1
    v_add_f32_dpp v47, v47, v47 quad_perm:[1,0,3,2] row_mask:0xf bank_mask:0xf
    v_cndmask_b32 v39, v46, v47, s[42:43]
    v_cvt_pk_bf16_f32 v39, v38, v39
    v_lshlrev_b32 v38, 16, v39
    v_and_b32 v39, 0xffff0000, v39
    v_mul_f32 v38, 0x3db504f3, v38
    v_mul_f32 v39, 0x3db504f3, v39
    v_cvt_pk_bf16_f32 v39, v38, v39
    v_lshlrev_b32 v38, 16, v39
    v_and_b32 v39, 0xffff0000, v39
    v_mov_b64 v[22:23], v[24:25]
    v_mov_b64 v[24:25], v[26:27]
    v_mov_b64 v[26:27], v[28:29]
    v_mov_b64 v[28:29], v[30:31]
    v_mov_b64 v[30:31], v[32:33]
    v_mov_b64 v[32:33], v[34:35]
    v_mov_b64 v[34:35], v[36:37]
    v_mov_b64 v[36:37], v[38:39]
    s_add_u32 s36, s36, 1
    s_cmp_lt_u32 s36, 8
    s_cbranch_scc1 L_kloop
    s_waitcnt vmcnt(4)
    buffer_load_dwordx4 v[236:239], v1, s[20:23], s51 offen nt
    v_sub_u32 v1, v1, v55
    v_bfi_b32 v1, s52, v1, v54
    v_max3_f32 v40, v22, v23, v24
    v_max3_f32 v41, v25, v26, v27
    v_max3_f32 v40, v40, v28, v29
    v_max3_f32 v41, v41, v30, v31
    v_max3_f32 v40, v40, v32, v33
    v_max3_f32 v41, v41, v34, v35
    v_max3_f32 v40, v40, v36, v37
    v_max_f32 v40, v40, v41
    s_nop 1
    v_max_f32_dpp v40, v40, v40 row_ror:8 row_mask:0xf bank_mask:0xf
    s_nop 1
    v_max_f32_dpp v40, v40, v40 row_ror:4 row_mask:0xf bank_mask:0xf
    s_nop 1
    v_max_f32_dpp v40, v40, v40 row_ror:2 row_mask:0xf bank_mask:0xf
    s_nop 1
    v_max_f32_dpp v40, v40, v40 row_ror:1 row_mask:0xf bank_mask:0xf
    v_mov_b32 v41, v40
    s_nop 1
    v_permlane16_swap_b32 v41, v40
    v_max_f32 v40, v40, v41
    v_mov_b32 v41, v40
    s_nop 1
    v_permlane32_swap_b32 v41, v40
    v_max_f32 v40, v40, v41
    s_waitcnt vmcnt(4)
    buffer_load_dwordx4 v[240:243], v1, s[20:23], s12 offen nt
    v_mul_f32 v42, s44, v40
    v_fma_f32 v22, v22, s44, -v42
    v_fma_f32 v23, v23, s44, -v42
    v_fma_f32 v24, v24, s44, -v42
    v_fma_f32 v25, v25, s44, -v42
    v_fma_f32 v26, v26, s44, -v42
    v_fma_f32 v27, v27, s44, -v42
    v_fma_f32 v28, v28, s44, -v42
    v_fma_f32 v29, v29, s44, -v42
    v_fma_f32 v30, v30, s44, -v42
    v_fma_f32 v31, v31, s44, -v42
    v_fma_f32 v32, v32, s44, -v42
    v_fma_f32 v33, v33, s44, -v42
    v_fma_f32 v34, v34, s44, -v42
    v_fma_f32 v35, v35, s44, -v42
    v_fma_f32 v36, v36, s44, -v42
    v_fma_f32 v37, v37, s44, -v42
    v_exp_f32 v22, v22
    v_exp_f32 v23, v23
    v_exp_f32 v24, v24
    v_exp_f32 v25, v25
    v_exp_f32 v26, v26
    v_exp_f32 v27, v27
    v_exp_f32 v28, v28
    v_exp_f32 v29, v29
    v_exp_f32 v30, v30
    v_exp_f32 v31, v31
    v_exp_f32 v32, v32
    v_exp_f32 v33, v33
    v_exp_f32 v34, v34
    v_exp_f32 v35, v35
    v_exp_f32 v36, v36
    v_exp_f32 v37, v37
    s_waitcnt vmcnt(4)
    buffer_load_dwordx4 v[244:247], v1, s[20:23], s13 offen nt
    v_add_f32 v43, v22, v23
    v_add_f32 v40, v24, v25
    v_add_f32 v43, v43, v26
    v_add_f32 v40, v40, v27
    v_add_f32 v43, v43, v28
    v_add_f32 v40, v40, v29
    v_add_f32 v43, v43, v30
    v_add_f32 v40, v40, v31
    v_add_f32 v43, v43, v32
    v_add_f32 v40, v40, v33
    v_add_f32 v43, v43, v34
    v_add_f32 v40, v40, v35
    v_add_f32 v43, v43, v36
    v_add_f32 v40, v40, v37
    v_add_f32 v43, v43, v40
    v_cvt_pk_bf16_f32 v64, v22, v23
    v_cvt_pk_bf16_f32 v65, v24, v25
    v_cvt_pk_bf16_f32 v66, v26, v27
    v_cvt_pk_bf16_f32 v67, v28, v29
    v_cvt_pk_bf16_f32 v68, v30, v31
    v_cvt_pk_bf16_f32 v69, v32, v33
    v_cvt_pk_bf16_f32 v70, v34, v35
    v_cvt_pk_bf16_f32 v71, v36, v37
    v_cvt_pk_bf16_f32 v22, v22, v22
    v_cvt_pk_bf16_f32 v23, v23, v23
    v_cvt_pk_bf16_f32 v24, v24, v24
    v_cvt_pk_bf16_f32 v25, v25, v25
    v_cvt_pk_bf16_f32 v26, v26, v26
    v_cvt_pk_bf16_f32 v27, v27, v27
    v_cvt_pk_bf16_f32 v28, v28, v28
    v_cvt_pk_bf16_f32 v29, v29, v29
    v_cvt_pk_bf16_f32 v30, v30, v30
    v_cvt_pk_bf16_f32 v31, v31, v31
    v_cvt_pk_bf16_f32 v32, v32, v32
    v_cvt_pk_bf16_f32 v33, v33, v33
    v_cvt_pk_bf16_f32 v34, v34, v34
    v_cvt_pk_bf16_f32 v35, v35, v35
    v_cvt_pk_bf16_f32 v36, v36, v36
    v_cvt_pk_bf16_f32 v37, v37, v37
    s_waitcnt vmcnt(4)
    buffer_load_dwordx4 v[248:251], v1, s[20:23], s14 offen nt
    v_mov_b32_dpp v67, v64 row_shl:12 row_mask:0xf bank_mask:1
    v_mov_b32_dpp v67, v65 row_shl:8 row_mask:0xf bank_mask:2
    v_mov_b32_dpp v67, v66 row_shl:4 row_mask:0xf bank_mask:4
    v_mov_b32_dpp v71, v68 row_shl:12 row_mask:0xf bank_mask:1
    v_mov_b32_dpp v71, v69 row_shl:8 row_mask:0xf bank_mask:2
    v_mov_b32_dpp v71, v70 row_shl:4 row_mask:0xf bank_mask:4
    s_lshl_b32 s33, s3, 9
    v_lshl_add_u32 v60, v0, 2, s33
    ds_write2st64_b32 v60, v67, v71 offset0:24 offset1:25
    v_add_f32_dpp v43, v43, v43 row_ror:8 row_mask:0xf bank_mask:0xf
    s_nop 1
    v_add_f32_dpp v43, v43, v43 row_ror:4 row_mask:0xf bank_mask:0xf
    s_nop 1
    v_add_f32_dpp v43, v43, v43 row_ror:2 row_mask:0xf bank_mask:0xf
    s_nop 1
    v_add_f32_dpp v43, v43, v43 row_ror:1 row_mask:0xf bank_mask:0xf
    v_mov_b32 v40, v43
    s_nop 1
    v_permlane16_swap_b32 v40, v43
    v_add_f32 v43, v43, v40
    v_mov_b32 v40, v43
    s_nop 1
    v_permlane32_swap_b32 v40, v43
    v_add_f32 v43, v43, v40
    s_mov_b64 exec, 1
    ds_write_b64 v50, v[42:43] offset:2048
    s_mov_b64 exec, -1
    v_and_b32_dpp v10, v22, v6 row_newbcast:0 row_mask:0xf bank_mask:0xf
    v_and_b32_dpp v11, v22, v7 row_newbcast:0 row_mask:0xf bank_mask:0xf
    v_and_b32_dpp v12, v22, v8 row_newbcast:0 row_mask:0xf bank_mask:0xf
    v_and_b32_dpp v13, v22, v9 row_newbcast:0 row_mask:0xf bank_mask:0xf
    v_lshl_add_u32 v40, v0, 4, s33
    s_mov_b32 s36, 0
.p2align 6
L_vloop:
    v_add_u32 v51, 1, v51
    s_mov_b64 exec, 1
    ds_write_b32 v50, v51 offset:2112
    s_mov_b64 exec, -1
    s_cmp_eq_u32 s36, 6
    s_cselect_b32 s66, 49152, 0
    s_sub_u32 s72, s72, s73
    s_add_u32 s73, s73, 4
    s_cmp_lt_i32 s72, 0
    s_cselect_b32 s74, 1, 0
    s_or_b32 s39, s39, s74
    s_cmp_gt_i32 s72, 1
    s_cselect_b32 s74, 256, 0
    s_or_b32 s39, s39, s74
    s_bitcmp1_b32 s39, 0
    s_cselect_b64 vcc, -1, 0
    s_bitcmp1_b32 s39, 8
    s_cbranch_scc1 L_hi1035
    s_cbranch_vccz L_mid1035
    s_waitcnt vmcnt(3)
L_mid1035:
    s_waitcnt vmcnt(4)
L_hi1035:
    s_waitcnt vmcnt(5)
    buffer_load_dwordx4 v[252:255], v1, s[20:23], s15 offen nt
    v_sub_u32 v1, v1, v55
    v_bfi_b32 v1, s52, v1, v54
    v_and_b32_dpp v14, v22, v6 row_newbcast:8 row_mask:0xf bank_mask:0xf
    v_and_b32_dpp v15, v22, v7 row_newbcast:8 row_mask:0xf bank_mask:0xf
    v_and_b32_dpp v16, v22, v8 row_newbcast:8 row_mask:0xf bank_mask:0xf
    v_and_b32_dpp v17, v22, v9 row_newbcast:8 row_mask:0xf bank_mask:0xf
    v_mfma_f32_16x16x32_bf16 v[18:21], v[10:13], v[128:131], v[18:21]
    s_cbranch_scc1 L_hi1050
    s_cbranch_vccz L_mid1050
    s_waitcnt vmcnt(3)
L_mid1050:
    s_waitcnt vmcnt(4)
L_hi1050:
    s_waitcnt vmcnt(5)
    buffer_load_dwordx4 v[128:131], v1, s[20:23], s48 offen nt
    v_and_b32_dpp v10, v22, v6 row_newbcast:4 row_mask:0xf bank_mask:0xf
    v_and_b32_dpp v11, v22, v7 row_newbcast:4 row_mask:0xf bank_mask:0xf
    v_and_b32_dpp v12, v22, v8 row_newbcast:4 row_mask:0xf bank_mask:0xf
    v_and_b32_dpp v13, v22, v9 row_newbcast:4 row_mask:0xf bank_mask:0xf
    v_mfma_f32_16x16x32_bf16 v[18:21], v[14:17], v[132:135], v[18:21]
    s_cbranch_scc1 L_hi1063
    s_cbranch_vccz L_mid1063
    s_waitcnt vmcnt(3)
L_mid1063:
    s_waitcnt vmcnt(4)
L_hi1063:
    s_waitcnt vmcnt(5)
    buffer_load_dwordx4 v[132:135], v1, s[20:23], s49 offen nt
    v_and_b32_dpp v14, v22, v6 row_newbcast:12 row_mask:0xf bank_mask:0xf
    v_and_b32_dpp v15, v22, v7 row_newbcast:12 row_mask:0xf bank_mask:0xf
    v_and_b32_dpp v16, v22, v8 row_newbcast:12 row_mask:0xf bank_mask:0xf
    v_and_b32_dpp v17, v22, v9 row_newbcast:12 row_mask:0xf bank_mask:0xf
    v_mfma_f32_16x16x32_bf16 v[18:21], v[10:13], v[136:139], v[18:21]
    s_cbranch_scc1 L_hi1076
    s_cbranch_vccz L_mid1076
    s_waitcnt vmcnt(3)
L_mid1076:
    s_waitcnt vmcnt(4)
L_hi1076:
    s_waitcnt vmcnt(5)
    buffer_load_dwordx4 v[136:139], v1, s[20:23], s50 offen nt
    v_and_b32_dpp v10, v22, v6 row_newbcast:2 row_mask:0xf bank_mask:0xf
    v_and_b32_dpp v11, v22, v7 row_newbcast:2 row_mask:0xf bank_mask:0xf
    v_and_b32_dpp v12, v22, v8 row_newbcast:2 row_mask:0xf bank_mask:0xf
    v_and_b32_dpp v13, v22, v9 row_newbcast:2 row_mask:0xf bank_mask:0xf
    v_mfma_f32_16x16x32_bf16 v[76:79], v[14:17], v[140:143], v[76:79]
    s_bitcmp1_b32 s39, 1
    s_cselect_b64 vcc, -1, 0
    s_bitcmp1_b32 s39, 9
    s_cbranch_scc1 L_hi1092
    s_cbranch_vccz L_mid1092
    s_waitcnt vmcnt(3)
L_mid1092:
    s_waitcnt vmcnt(4)
L_hi1092:
    s_waitcnt vmcnt(5)
    buffer_load_dwordx4 v[140:143], v1, s[20:23], s51 offen nt
    v_sub_u32 v1, v1, v55
    v_bfi_b32 v1, s52, v1, v54
    v_and_b32_dpp v14, v22, v6 row_newbcast:10 row_mask:0xf bank_mask:0xf
    v_and_b32_dpp v15, v22, v7 row_newbcast:10 row_mask:0xf bank_mask:0xf
    v_and_b32_dpp v16, v22, v8 row_newbcast:10 row_mask:0xf bank_mask:0xf
    v_and_b32_dpp v17, v22, v9 row_newbcast:10 row_mask:0xf bank_mask:0xf
    v_mfma_f32_16x16x32_bf16 v[18:21], v[10:13], v[144:147], v[18:21]
    s_cbranch_scc1 L_hi1107
    s_cbranch_vccz L_mid1107
    s_waitcnt vmcnt(3)
L_mid1107:
    s_waitcnt vmcnt(4)
L_hi1107:
    s_waitcnt vmcnt(5)
    buffer_load_dwordx4 v[144:147], v1, s[20:23], s12 offen nt
    v_and_b32_dpp v10, v22, v6 row_newbcast:6 row_mask:0xf bank_mask:0xf
    v_and_b32_dpp v11, v22, v7 row_newbcast:6 row_mask:0xf bank_mask:0xf
    v_and_b32_dpp v12, v22, v8 row_newbcast:6 row_mask:0xf bank_mask:0xf
    v_and_b32_dpp v13, v22, v9 row_newbcast:6 row_mask:0xf bank_mask:0xf
    v_mfma_f32_16x16x32_bf16 v[18:21], v[14:17], v[148:151], v[18:21]
    ds_read_b32 v52, v59 offset:512
    s_mov_b64 exec, 1
    ds_add_rtn_u32 v72, v53, v73 offset:2188
    s_mov_b64 exec, -1
    s_cbranch_scc1 L_hi1124
    s_cbranch_vccz L_mid1124
    s_waitcnt vmcnt(3)
L_mid1124:
    s_waitcnt vmcnt(4)
L_hi1124:
    s_waitcnt vmcnt(5)
    buffer_load_dwordx4 v[148:151], v1, s[20:23], s13 offen nt
    v_and_b32_dpp v14, v22, v6 row_newbcast:14 row_mask:0xf bank_mask:0xf
    v_and_b32_dpp v15, v22, v7 row_newbcast:14 row_mask:0xf bank_mask:0xf
    v_and_b32_dpp v16, v22, v8 row_newbcast:14 row_mask:0xf bank_mask:0xf
    v_and_b32_dpp v17, v22, v9 row_newbcast:14 row_mask:0xf bank_mask:0xf
    v_mfma_f32_16x16x32_bf16 v[18:21], v[10:13], v[152:155], v[18:21]
    s_waitcnt lgkmcnt(0)
    v_readfirstlane_b32 s72, v72
    v_readfirstlane_b32 s39, v52
    s_cbranch_scc1 L_hi1140
    s_cbranch_vccz L_mid1140
    s_waitcnt vmcnt(3)
L_mid1140:
    s_waitcnt vmcnt(4)
L_hi1140:
    s_waitcnt vmcnt(5)
    buffer_load_dwordx4 v[152:155], v1, s[20:23], s14 offen nt
    v_and_b32_dpp v10, v22, v6 row_newbcast:1 row_mask:0xf bank_mask:0xf
    v_and_b32_dpp v11, v22, v7 row_newbcast:1 row_mask:0xf bank_mask:0xf
    v_and_b32_dpp v12, v22, v8 row_newbcast:1 row_mask:0xf bank_mask:0xf
    v_and_b32_dpp v13, v22, v9 row_newbcast:1 row_mask:0xf bank_mask:0xf
    v_mfma_f32_16x16x32_bf16 v[76:79], v[14:17], v[156:159], v[76:79]
    s_sub_u32 s72, s72, s73
    s_add_u32 s73, s73, 4
    s_cmp_lt_i32 s72, 0
    s_cselect_b32 s74, 4, 0
    s_or_b32 s39, s39, s74
    s_cmp_gt_i32 s72, 1
    s_cselect_b32 s74, 1024, 0
    s_or_b32 s39, s39, s74
    s_bitcmp1_b32 s39, 2
    s_cselect_b64 vcc, -1, 0
    s_bitcmp1_b32 s39, 10
    s_cbranch_scc1 L_hi1164
    s_cbranch_vccz L_mid1164
    s_waitcnt vmcnt(3)
L_mid1164:
    s_waitcnt vmcnt(4)
L_hi1164:
    s_waitcnt vmcnt(5)
    buffer_load_dwordx4 v[156:159], v1, s[20:23], s15 offen nt
    v_sub_u32 v1, v1, v55
    v_bfi_b32 v1, s52, v1, v54
    v_and_b32_dpp v14, v22, v6 row_newbcast:9 row_mask:0xf bank_mask:0xf
    v_and_b32_dpp v15, v22, v7 row_newbcast:9 row_mask:0xf bank_mask:0xf
    v_and_b32_dpp v16, v22, v8 row_newbcast:9 row_mask:0xf bank_mask:0xf
    v_and_b32_dpp v17, v22, v9 row_newbcast:9 row_mask:0xf bank_mask:0xf
    v_mfma_f32_16x16x32_bf16 v[18:21], v[10:13], v[160:163], v[18:21]
    s_cbranch_scc1 L_hi1179
    s_cbranch_vccz L_mid1179
    s_waitcnt vmcnt(3)
L_mid1179:
    s_waitcnt vmcnt(4)
L_hi1179:
    s_waitcnt vmcnt(5)
    buffer_load_dwordx4 v[160:163], v1, s[20:23], s48 offen nt
    v_and_b32_dpp v10, v22, v6 row_newbcast:5 row_mask:0xf bank_mask:0xf
    v_and_b32_dpp v11, v22, v7 row_newbcast:5 row_mask:0xf bank_mask:0xf
    v_and_b32_dpp v12, v22, v8 row_newbcast:5 row_mask:0xf bank_mask:0xf
    v_and_b32_dpp v13, v22, v9 row_newbcast:5 row_mask:0xf bank_mask:0xf
    v_mfma_f32_16x16x32_bf16 v[18:21], v[14:17], v[164:167], v[18:21]
    s_cbranch_scc1 L_hi1192
    s_cbranch_vccz L_mid1192
    s_waitcnt vmcnt(3)
L_mid1192:
    s_waitcnt vmcnt(4)
L_hi1192:
    s_waitcnt vmcnt(5)
    buffer_load_dwordx4 v[164:167], v1, s[20:23], s49 offen nt
    v_and_b32_dpp v14, v22, v6 row_newbcast:13 row_mask:0xf bank_mask:0xf
    v_and_b32_dpp v15, v22, v7 row_newbcast:13 row_mask:0xf bank_mask:0xf
    v_and_b32_dpp v16, v22, v8 row_newbcast:13 row_mask:0xf bank_mask:0xf
    v_and_b32_dpp v17, v22, v9 row_newbcast:13 row_mask:0xf bank_mask:0xf
    v_mfma_f32_16x16x32_bf16 v[18:21], v[10:13], v[168:171], v[18:21]
    s_cbranch_scc1 L_hi1205
    s_cbranch_vccz L_mid1205
    s_waitcnt vmcnt(3)
L_mid1205:
    s_waitcnt vmcnt(4)
L_hi1205:
    s_waitcnt vmcnt(5)
    buffer_load_dwordx4 v[168:171], v1, s[20:23], s50 offen nt
    v_and_b32_dpp v10, v22, v6 row_newbcast:3 row_mask:0xf bank_mask:0xf
    v_and_b32_dpp v11, v22, v7 row_newbcast:3 row_mask:0xf bank_mask:0xf
    v_and_b32_dpp v12, v22, v8 row_newbcast:3 row_mask:0xf bank_mask:0xf
    v_and_b32_dpp v13, v22, v9 row_newbcast:3 row_mask:0xf bank_mask:0xf
    v_mfma_f32_16x16x32_bf16 v[76:79], v[14:17], v[172:175], v[76:79]
    s_bitcmp1_b32 s39, 3
    s_cselect_b64 vcc, -1, 0
    s_bitcmp1_b32 s39, 11
    s_cbranch_scc1 L_hi1221
    s_cbranch_vccz L_mid1221
    s_waitcnt vmcnt(3)
L_mid1221:
    s_waitcnt vmcnt(4)
L_hi1221:
    s_waitcnt vmcnt(5)
    buffer_load_dwordx4 v[172:175], v1, s[20:23], s51 offen nt
    v_sub_u32 v1, v1, v55
    v_bfi_b32 v1, s52, v1, v54
    v_and_b32_dpp v14, v22, v6 row_newbcast:11 row_mask:0xf bank_mask:0xf
    v_and_b32_dpp v15, v22, v7 row_newbcast:11 row_mask:0xf bank_mask:0xf
    v_and_b32_dpp v16, v22, v8 row_newbcast:11 row_mask:0xf bank_mask:0xf
    v_and_b32_dpp v17, v22, v9 row_newbcast:11 row_mask:0xf bank_mask:0xf
    v_mfma_f32_16x16x32_bf16 v[18:21], v[10:13], v[176:179], v[18:21]
    s_cbranch_scc1 L_hi1236
    s_cbranch_vccz L_mid1236
    s_waitcnt vmcnt(3)
L_mid1236:
    s_waitcnt vmcnt(4)
L_hi1236:
    s_waitcnt vmcnt(5)
    buffer_load_dwordx4 v[176:179], v1, s[20:23], s12 offen nt
    v_and_b32_dpp v10, v22, v6 row_newbcast:7 row_mask:0xf bank_mask:0xf
    v_and_b32_dpp v11, v22, v7 row_newbcast:7 row_mask:0xf bank_mask:0xf
    v_and_b32_dpp v12, v22, v8 row_newbcast:7 row_mask:0xf bank_mask:0xf
    v_and_b32_dpp v13, v22, v9 row_newbcast:7 row_mask:0xf bank_mask:0xf
    v_mfma_f32_16x16x32_bf16 v[18:21], v[14:17], v[180:183], v[18:21]
    ds_read_b32 v52, v59 offset:512
    s_mov_b64 exec, 1
    ds_add_rtn_u32 v72, v53, v73 offset:2188
    s_mov_b64 exec, -1
    s_cbranch_scc1 L_hi1253
    s_cbranch_vccz L_mid1253
    s_waitcnt vmcnt(3)
L_mid1253:
    s_waitcnt vmcnt(4)
L_hi1253:
    s_waitcnt vmcnt(5)
    buffer_load_dwordx4 v[180:183], v1, s[20:23], s13 offen nt
    v_and_b32_dpp v14, v22, v6 row_newbcast:15 row_mask:0xf bank_mask:0xf
    v_and_b32_dpp v15, v22, v7 row_newbcast:15 row_mask:0xf bank_mask:0xf
    v_and_b32_dpp v16, v22, v8 row_newbcast:15 row_mask:0xf bank_mask:0xf
    v_and_b32_dpp v17, v22, v9 row_newbcast:15 row_mask:0xf bank_mask:0xf
    v_mfma_f32_16x16x32_bf16 v[18:21], v[10:13], v[184:187], v[18:21]
    s_waitcnt lgkmcnt(0)
    v_readfirstlane_b32 s72, v72
    v_readfirstlane_b32 s39, v52
    s_cbranch_scc1 L_hi1269
    s_cbranch_vccz L_mid1269
    s_waitcnt vmcnt(3)
L_mid1269:
    s_waitcnt vmcnt(4)
L_hi1269:
    s_waitcnt vmcnt(5)
    buffer_load_dwordx4 v[184:187], v1, s[20:23], s14 offen nt
    v_and_b32_dpp v10, v23, v6 row_newbcast:0 row_mask:0xf bank_mask:0xf
    v_and_b32_dpp v11, v23, v7 row_newbcast:0 row_mask:0xf bank_mask:0xf
    v_and_b32_dpp v12, v23, v8 row_newbcast:0 row_mask:0xf bank_mask:0xf
    v_and_b32_dpp v13, v23, v9 row_newbcast:0 row_mask:0xf bank_mask:0xf
    v_mfma_f32_16x16x32_bf16 v[76:79], v[14:17], v[188:191], v[76:79]
    s_cmp_eq_u32 s36, s54
    s_cbranch_scc1 L_swap
L_swap_back:
    s_sub_u32 s72, s72, s73
    s_add_u32 s73, s73, 4
    s_cmp_lt_i32 s72, 0
    s_cselect_b32 s74, 16, 0
    s_or_b32 s39, s39, s74
    s_cmp_gt_i32 s72, 1
    s_cselect_b32 s74, 4096, 0
    s_or_b32 s39, s39, s74
    s_bitcmp1_b32 s39, 4
    s_cselect_b64 vcc, -1, 0
    s_bitcmp1_b32 s39, 12
    s_cbranch_scc1 L_hi1296
    s_cbranch_vccz L_mid1296
    s_waitcnt vmcnt(3)
L_mid1296:
    s_waitcnt vmcnt(4)
L_hi1296:
    s_waitcnt vmcnt(5)
    buffer_load_dwordx4 v[188:191], v1, s[20:23], s15 offen nt
    v_sub_u32 v1, v1, v55
    v_bfi_b32 v1, s52, v1, v54
    s_cmp_eq_u32 s36, s55
    s_cbranch_scc1 L_tonear
L_tonear_back:
    s_bitcmp1_b32 s39, 12
    v_and_b32_dpp v14, v23, v6 row_newbcast:8 row_mask:0xf bank_mask:0xf
    v_and_b32_dpp v15, v23, v7 row_newbcast:8 row_mask:0xf bank_mask:0xf
    v_and_b32_dpp v16, v23, v8 row_newbcast:8 row_mask:0xf bank_mask:0xf
    v_and_b32_dpp v17, v23, v9 row_newbcast:8 row_mask:0xf bank_mask:0xf
    v_mfma_f32_16x16x32_bf16 v[18:21], v[10:13], v[192:195], v[18:21]
    s_cbranch_scc1 L_hi1315
    s_cbranch_vccz L_mid1315
    s_waitcnt vmcnt(3)
L_mid1315:
    s_waitcnt vmcnt(4)
L_hi1315:
    s_waitcnt vmcnt(5)
    buffer_load_dwordx4 v[192:195], v1, s[20:23], s48 offen nt
    v_and_b32_dpp v10, v23, v6 row_newbcast:4 row_mask:0xf bank_mask:0xf
    v_and_b32_dpp v11, v23, v7 row_newbcast:4 row_mask:0xf bank_mask:0xf
    v_and_b32_dpp v12, v23, v8 row_newbcast:4 row_mask:0xf bank_mask:0xf
    v_and_b32_dpp v13, v23, v9 row_newbcast:4 row_mask:0xf bank_mask:0xf
    v_mfma_f32_16x16x32_bf16 v[18:21], v[14:17], v[196:199], v[18:21]
    s_cbranch_scc1 L_hi1328
    s_cbranch_vccz L_mid1328
    s_waitcnt vmcnt(3)
L_mid1328:
    s_waitcnt vmcnt(4)
L_hi1328:
    s_waitcnt vmcnt(5)
    buffer_load_dwordx4 v[196:199], v1, s[20:23], s49 offen nt
    v_and_b32_dpp v14, v23, v6 row_newbcast:12 row_mask:0xf bank_mask:0xf
    v_and_b32_dpp v15, v23, v7 row_newbcast:12 row_mask:0xf bank_mask:0xf
    v_and_b32_dpp v16, v23, v8 row_newbcast:12 row_mask:0xf bank_mask:0xf
    v_and_b32_dpp v17, v23, v9 row_newbcast:12 row_mask:0xf bank_mask:0xf
    v_mfma_f32_16x16x32_bf16 v[18:21], v[10:13], v[200:203], v[18:21]
    s_cbranch_scc1 L_hi1341
    s_cbranch_vccz L_mid1341
    s_waitcnt vmcnt(3)
L_mid1341:
    s_waitcnt vmcnt(4)
L_hi1341:
    s_waitcnt vmcnt(5)
    buffer_load_dwordx4 v[200:203], v1, s[20:23], s50 offen nt
    v_and_b32_dpp v10, v23, v6 row_newbcast:2 row_mask:0xf bank_mask:0xf
    v_and_b32_dpp v11, v23, v7 row_newbcast:2 row_mask:0xf bank_mask:0xf
    v_and_b32_dpp v12, v23, v8 row_newbcast:2 row_mask:0xf bank_mask:0xf
    v_and_b32_dpp v13, v23, v9 row_newbcast:2 row_mask:0xf bank_mask:0xf
    v_mfma_f32_16x16x32_bf16 v[76:79], v[14:17], v[204:207], v[76:79]
    s_bitcmp1_b32 s39, 5
    s_cselect_b64 vcc, -1, 0
    s_bitcmp1_b32 s39, 13
    s_cbranch_scc1 L_hi1357
    s_cbranch_vccz L_mid1357
    s_waitcnt vmcnt(3)
L_mid1357:
    s_waitcnt vmcnt(4)
L_hi1357:
    s_waitcnt vmcnt(5)
    buffer_load_dwordx4 v[204:207], v1, s[20:23], s51 offen nt
    v_sub_u32 v1, v1, v55
    v_bfi_b32 v1, s52, v1, v54
    v_and_b32_dpp v14, v23, v6 row_newbcast:10 row_mask:0xf bank_mask:0xf
    v_and_b32_dpp v15, v23, v7 row_newbcast:10 row_mask:0xf bank_mask:0xf
    v_and_b32_dpp v16, v23, v8 row_newbcast:10 row_mask:0xf bank_mask:0xf
    v_and_b32_dpp v17, v23, v9 row_newbcast:10 row_mask:0xf bank_mask:0xf
    v_mfma_f32_16x16x32_bf16 v[18:21], v[10:13], v[208:211], v[18:21]
    s_cbranch_scc1 L_hi1372
    s_cbranch_vccz L_mid1372
    s_waitcnt vmcnt(3)
L_mid1372:
    s_waitcnt vmcnt(4)
L_hi1372:
    s_waitcnt vmcnt(5)
    buffer_load_dwordx4 v[208:211], v1, s[20:23], s12 offen nt
    v_and_b32_dpp v10, v23, v6 row_newbcast:6 row_mask:0xf bank_mask:0xf
    v_and_b32_dpp v11, v23, v7 row_newbcast:6 row_mask:0xf bank_mask:0xf
    v_and_b32_dpp v12, v23, v8 row_newbcast:6 row_mask:0xf bank_mask:0xf
    v_and_b32_dpp v13, v23, v9 row_newbcast:6 row_mask:0xf bank_mask:0xf
    v_mfma_f32_16x16x32_bf16 v[18:21], v[14:17], v[212:215], v[18:21]
    ds_read_b32 v52, v59 offset:512
    s_mov_b64 exec, 1
    ds_add_rtn_u32 v72, v53, v73 offset:2188
    s_mov_b64 exec, -1
    s_cbranch_scc1 L_hi1389
    s_cbranch_vccz L_mid1389
    s_waitcnt vmcnt(3)
L_mid1389:
    s_waitcnt vmcnt(4)
L_hi1389:
    s_waitcnt vmcnt(5)
    buffer_load_dwordx4 v[212:215], v1, s[20:23], s13 offen nt
    v_and_b32_dpp v14, v23, v6 row_newbcast:14 row_mask:0xf bank_mask:0xf
    v_and_b32_dpp v15, v23, v7 row_newbcast:14 row_mask:0xf bank_mask:0xf
    v_and_b32_dpp v16, v23, v8 row_newbcast:14 row_mask:0xf bank_mask:0xf
    v_and_b32_dpp v17, v23, v9 row_newbcast:14 row_mask:0xf bank_mask:0xf
    v_mfma_f32_16x16x32_bf16 v[18:21], v[10:13], v[216:219], v[18:21]
    s_waitcnt lgkmcnt(0)
    v_readfirstlane_b32 s72, v72
    v_readfirstlane_b32 s39, v52
    s_cbranch_scc1 L_hi1405
    s_cbranch_vccz L_mid1405
    s_waitcnt vmcnt(3)
L_mid1405:
    s_waitcnt vmcnt(4)
L_hi1405:
    s_waitcnt vmcnt(5)
    buffer_load_dwordx4 v[216:219], v1, s[20:23], s14 offen nt
    v_and_b32_dpp v10, v23, v6 row_newbcast:1 row_mask:0xf bank_mask:0xf
    v_and_b32_dpp v11, v23, v7 row_newbcast:1 row_mask:0xf bank_mask:0xf
    v_and_b32_dpp v12, v23, v8 row_newbcast:1 row_mask:0xf bank_mask:0xf
    v_and_b32_dpp v13, v23, v9 row_newbcast:1 row_mask:0xf bank_mask:0xf
    v_mfma_f32_16x16x32_bf16 v[76:79], v[14:17], v[220:223], v[76:79]
    s_sub_u32 s72, s72, s73
    s_add_u32 s73, s73, 4
    s_cmp_lt_i32 s72, 0
    s_cselect_b32 s74, 64, 0
    s_or_b32 s39, s39, s74
    s_cmp_gt_i32 s72, 1
    s_cselect_b32 s74, 16384, 0
    s_or_b32 s39, s39, s74
    s_or_b32 s39, s39, s66
    s_bitcmp1_b32 s39, 6
    s_cselect_b64 vcc, -1, 0
    s_bitcmp1_b32 s39, 14
    s_cbranch_scc1 L_hi1430
    s_cbranch_vccz L_mid1430
    s_waitcnt vmcnt(3)
L_mid1430:
    s_waitcnt vmcnt(4)
L_hi1430:
    s_waitcnt vmcnt(5)
    buffer_load_dwordx4 v[220:223], v1, s[20:23], s15 offen nt
    v_sub_u32 v1, v1, v55
    v_bfi_b32 v1, s52, v1, v54
    v_and_b32_dpp v14, v23, v6 row_newbcast:9 row_mask:0xf bank_mask:0xf
    v_and_b32_dpp v15, v23, v7 row_newbcast:9 row_mask:0xf bank_mask:0xf
    v_and_b32_dpp v16, v23, v8 row_newbcast:9 row_mask:0xf bank_mask:0xf
    v_and_b32_dpp v17, v23, v9 row_newbcast:9 row_mask:0xf bank_mask:0xf
    v_mfma_f32_16x16x32_bf16 v[18:21], v[10:13], v[224:227], v[18:21]
    s_cbranch_scc1 L_hi1445
    s_cbranch_vccz L_mid1445
    s_waitcnt vmcnt(3)
L_mid1445:
    s_waitcnt vmcnt(4)
L_hi1445:
    s_waitcnt vmcnt(5)
    buffer_load_dwordx4 v[224:227], v1, s[20:23], s48 offen nt
    v_and_b32_dpp v10, v23, v6 row_newbcast:5 row_mask:0xf bank_mask:0xf
    v_and_b32_dpp v11, v23, v7 row_newbcast:5 row_mask:0xf bank_mask:0xf
    v_and_b32_dpp v12, v23, v8 row_newbcast:5 row_mask:0xf bank_mask:0xf
    v_and_b32_dpp v13, v23, v9 row_newbcast:5 row_mask:0xf bank_mask:0xf
    v_mfma_f32_16x16x32_bf16 v[18:21], v[14:17], v[228:231], v[18:21]
    s_cbranch_scc1 L_hi1458
    s_cbranch_vccz L_mid1458
    s_waitcnt vmcnt(3)
L_mid1458:
    s_waitcnt vmcnt(4)
L_hi1458:
    s_waitcnt vmcnt(5)
    buffer_load_dwordx4 v[228:231], v1, s[20:23], s49 offen nt
    v_and_b32_dpp v14, v23, v6 row_newbcast:13 row_mask:0xf bank_mask:0xf
    v_and_b32_dpp v15, v23, v7 row_newbcast:13 row_mask:0xf bank_mask:0xf
    v_and_b32_dpp v16, v23, v8 row_newbcast:13 row_mask:0xf bank_mask:0xf
    v_and_b32_dpp v17, v23, v9 row_newbcast:13 row_mask:0xf bank_mask:0xf
    v_mfma_f32_16x16x32_bf16 v[18:21], v[10:13], v[232:235], v[18:21]
    s_cbranch_scc1 L_hi1471
    s_cbranch_vccz L_mid1471
    s_waitcnt vmcnt(3)
L_mid1471:
    s_waitcnt vmcnt(4)
L_hi1471:
    s_waitcnt vmcnt(5)
    buffer_load_dwordx4 v[232:235], v1, s[20:23], s50 offen nt
    v_and_b32_dpp v10, v23, v6 row_newbcast:3 row_mask:0xf bank_mask:0xf
    v_and_b32_dpp v11, v23, v7 row_newbcast:3 row_mask:0xf bank_mask:0xf
    v_and_b32_dpp v12, v23, v8 row_newbcast:3 row_mask:0xf bank_mask:0xf
    v_and_b32_dpp v13, v23, v9 row_newbcast:3 row_mask:0xf bank_mask:0xf
    v_mfma_f32_16x16x32_bf16 v[76:79], v[14:17], v[236:239], v[76:79]
    s_bitcmp1_b32 s39, 7
    s_cselect_b64 vcc, -1, 0
    s_bitcmp1_b32 s39, 15
    s_cbranch_scc1 L_hi1487
    s_cbranch_vccz L_mid1487
    s_waitcnt vmcnt(3)
L_mid1487:
    s_waitcnt vmcnt(4)
L_hi1487:
    s_waitcnt vmcnt(7)
    buffer_load_dwordx4 v[236:239], v1, s[20:23], s51 offen nt
    v_sub_u32 v1, v1, v55
    v_bfi_b32 v1, s52, v1, v54
    v_and_b32_dpp v14, v23, v6 row_newbcast:11 row_mask:0xf bank_mask:0xf
    v_and_b32_dpp v15, v23, v7 row_newbcast:11 row_mask:0xf bank_mask:0xf
    v_and_b32_dpp v16, v23, v8 row_newbcast:11 row_mask:0xf bank_mask:0xf
    v_and_b32_dpp v17, v23, v9 row_newbcast:11 row_mask:0xf bank_mask:0xf
    v_mfma_f32_16x16x32_bf16 v[18:21], v[10:13], v[240:243], v[18:21]
    s_cbranch_scc1 L_hi1502
    s_cbranch_vccz L_mid1502
    s_waitcnt vmcnt(3)
L_mid1502:
    s_waitcnt vmcnt(4)
L_hi1502:
    s_waitcnt vmcnt(7)
    buffer_load_dwordx4 v[240:243], v1, s[20:23], s12 offen nt
    v_and_b32_dpp v10, v23, v6 row_newbcast:7 row_mask:0xf bank_mask:0xf
    v_and_b32_dpp v11, v23, v7 row_newbcast:7 row_mask:0xf bank_mask:0xf
    v_and_b32_dpp v12, v23, v8 row_newbcast:7 row_mask:0xf bank_mask:0xf
    v_and_b32_dpp v13, v23, v9 row_newbcast:7 row_mask:0xf bank_mask:0xf
    v_mfma_f32_16x16x32_bf16 v[18:21], v[14:17], v[244:247], v[18:21]
    ds_read_b32 v52, v59 offset:512
    s_mov_b64 exec, 1
    ds_add_rtn_u32 v72, v53, v73 offset:2188
    s_mov_b64 exec, -1
    s_cbranch_scc1 L_hi1519
    s_cbranch_vccz L_mid1519
    s_waitcnt vmcnt(3)
L_mid1519:
    s_waitcnt vmcnt(4)
L_hi1519:
    s_waitcnt vmcnt(7)
    buffer_load_dwordx4 v[244:247], v1, s[20:23], s13 offen nt
    v_and_b32_dpp v14, v23, v6 row_newbcast:15 row_mask:0xf bank_mask:0xf
    v_and_b32_dpp v15, v23, v7 row_newbcast:15 row_mask:0xf bank_mask:0xf
    v_and_b32_dpp v16, v23, v8 row_newbcast:15 row_mask:0xf bank_mask:0xf
    v_and_b32_dpp v17, v23, v9 row_newbcast:15 row_mask:0xf bank_mask:0xf
    v_mfma_f32_16x16x32_bf16 v[18:21], v[10:13], v[248:251], v[18:21]
    s_waitcnt lgkmcnt(0)
    v_readfirstlane_b32 s72, v72
    v_readfirstlane_b32 s39, v52
    s_cbranch_scc1 L_hi1535
    s_cbranch_vccz L_mid1535
    s_waitcnt vmcnt(3)
L_mid1535:
    s_waitcnt vmcnt(4)
L_hi1535:
    s_waitcnt vmcnt(7)
    buffer_load_dwordx4 v[248:251], v1, s[20:23], s14 offen nt
    v_and_b32_dpp v10, v24, v6 row_newbcast:0 row_mask:0xf bank_mask:0xf
    v_and_b32_dpp v11, v24, v7 row_newbcast:0 row_mask:0xf bank_mask:0xf
    v_and_b32_dpp v12, v24, v8 row_newbcast:0 row_mask:0xf bank_mask:0xf
    v_and_b32_dpp v13, v24, v9 row_newbcast:0 row_mask:0xf bank_mask:0xf
    v_mfma_f32_16x16x32_bf16 v[76:79], v[14:17], v[252:255], v[76:79]
    v_mov_b64 v[22:23], v[24:25]
    v_mov_b64 v[24:25], v[26:27]
    v_mov_b64 v[26:27], v[28:29]
    v_mov_b64 v[28:29], v[30:31]
    v_mov_b64 v[30:31], v[32:33]
    v_mov_b64 v[32:33], v[34:35]
    v_mov_b64 v[34:35], v[36:37]
    s_add_u32 s36, s36, 1
    s_cmp_lt_u32 s36, 7
    s_cbranch_scc1 L_vloop
    buffer_load_dwordx4 v[252:255], v1, s[20:23], s15 offen nt
    s_mov_b32 s39, 16777216
L_waitfac:
    ds_read_b64 v[42:43], v50 offset:2208
    s_sub_u32 s39, s39, 1
    s_cbranch_scc1 L_drain1
    s_waitcnt lgkmcnt(0)
    v_cmp_eq_u32 vcc, -1, v43
    s_nop 0
    s_cbranch_vccnz L_waitfac
L_drain1:
    v_and_b32_dpp v14, v22, v6 row_newbcast:8 row_mask:0xf bank_mask:0xf
    v_and_b32_dpp v15, v22, v7 row_newbcast:8 row_mask:0xf bank_mask:0xf
    v_and_b32_dpp v16, v22, v8 row_newbcast:8 row_mask:0xf bank_mask:0xf
    v_and_b32_dpp v17, v22, v9 row_newbcast:8 row_mask:0xf bank_mask:0xf
    v_mfma_f32_16x16x32_bf16 v[18:21], v[10:13], v[128:131], v[18:21]
    v_and_b32_dpp v10, v22, v6 row_newbcast:4 row_mask:0xf bank_mask:0xf
    v_and_b32_dpp v11, v22, v7 row_newbcast:4 row_mask:0xf bank_mask:0xf
    v_and_b32_dpp v12, v22, v8 row_newbcast:4 row_mask:0xf bank_mask:0xf
    v_and_b32_dpp v13, v22, v9 row_newbcast:4 row_mask:0xf bank_mask:0xf
    v_mfma_f32_16x16x32_bf16 v[18:21], v[14:17], v[132:135], v[18:21]
    v_and_b32_dpp v14, v22, v6 row_newbcast:12 row_mask:0xf bank_mask:0xf
    v_and_b32_dpp v15, v22, v7 row_newbcast:12 row_mask:0xf bank_mask:0xf
    v_and_b32_dpp v16, v22, v8 row_newbcast:12 row_mask:0xf bank_mask:0xf
    v_and_b32_dpp v17, v22, v9 row_newbcast:12 row_mask:0xf bank_mask:0xf
    v_mfma_f32_16x16x32_bf16 v[18:21], v[10:13], v[136:139], v[18:21]
    v_and_b32_dpp v10, v22, v6 row_newbcast:2 row_mask:0xf bank_mask:0xf
    v_and_b32_dpp v11, v22, v7 row_newbcast:2 row_mask:0xf bank_mask:0xf
    v_and_b32_dpp v12, v22, v8 row_newbcast:2 row_mask:0xf bank_mask:0xf
    v_and_b32_dpp v13, v22, v9 row_newbcast:2 row_mask:0xf bank_mask:0xf
    v_mfma_f32_16x16x32_bf16 v[76:79], v[14:17], v[140:143], v[76:79]
    v_and_b32_dpp v14, v22, v6 row_newbcast:10 row_mask:0xf bank_mask:0xf
    v_and_b32_dpp v15, v22, v7 row_newbcast:10 row_mask:0xf bank_mask:0xf
    v_and_b32_dpp v16, v22, v8 row_newbcast:10 row_mask:0xf bank_mask:0xf
    v_and_b32_dpp v17, v22, v9 row_newbcast:10 row_mask:0xf bank_mask:0xf
    v_mfma_f32_16x16x32_bf16 v[18:21], v[10:13], v[144:147], v[18:21]
    v_and_b32_dpp v10, v22, v6 row_newbcast:6 row_mask:0xf bank_mask:0xf
    v_and_b32_dpp v11, v22, v7 row_newbcast:6 row_mask:0xf bank_mask:0xf
    v_and_b32_dpp v12, v22, v8 row_newbcast:6 row_mask:0xf bank_mask:0xf
    v_and_b32_dpp v13, v22, v9 row_newbcast:6 row_mask:0xf bank_mask:0xf
    v_mfma_f32_16x16x32_bf16 v[18:21], v[14:17], v[148:151], v[18:21]
    v_and_b32_dpp v14, v22, v6 row_newbcast:14 row_mask:0xf bank_mask:0xf
    v_and_b32_dpp v15, v22, v7 row_newbcast:14 row_mask:0xf bank_mask:0xf
    v_and_b32_dpp v16, v22, v8 row_newbcast:14 row_mask:0xf bank_mask:0xf
    v_and_b32_dpp v17, v22, v9 row_newbcast:14 row_mask:0xf bank_mask:0xf
    v_mfma_f32_16x16x32_bf16 v[18:21], v[10:13], v[152:155], v[18:21]
    v_and_b32_dpp v10, v22, v6 row_newbcast:1 row_mask:0xf bank_mask:0xf
    v_and_b32_dpp v11, v22, v7 row_newbcast:1 row_mask:0xf bank_mask:0xf
    v_and_b32_dpp v12, v22, v8 row_newbcast:1 row_mask:0xf bank_mask:0xf
    v_and_b32_dpp v13, v22, v9 row_newbcast:1 row_mask:0xf bank_mask:0xf
    v_mfma_f32_16x16x32_bf16 v[76:79], v[14:17], v[156:159], v[76:79]
    v_and_b32_dpp v14, v22, v6 row_newbcast:9 row_mask:0xf bank_mask:0xf
    v_and_b32_dpp v15, v22, v7 row_newbcast:9 row_mask:0xf bank_mask:0xf
    v_and_b32_dpp v16, v22, v8 row_newbcast:9 row_mask:0xf bank_mask:0xf
    v_and_b32_dpp v17, v22, v9 row_newbcast:9 row_mask:0xf bank_mask:0xf
    v_mfma_f32_16x16x32_bf16 v[18:21], v[10:13], v[160:163], v[18:21]
    v_and_b32_dpp v10, v22, v6 row_newbcast:5 row_mask:0xf bank_mask:0xf
    v_and_b32_dpp v11, v22, v7 row_newbcast:5 row_mask:0xf bank_mask:0xf
    v_and_b32_dpp v12, v22, v8 row_newbcast:5 row_mask:0xf bank_mask:0xf
    v_and_b32_dpp v13, v22, v9 row_newbcast:5 row_mask:0xf bank_mask:0xf
    v_mfma_f32_16x16x32_bf16 v[18:21], v[14:17], v[164:167], v[18:21]
    v_and_b32_dpp v14, v22, v6 row_newbcast:13 row_mask:0xf bank_mask:0xf
    v_and_b32_dpp v15, v22, v7 row_newbcast:13 row_mask:0xf bank_mask:0xf
    v_and_b32_dpp v16, v22, v8 row_newbcast:13 row_mask:0xf bank_mask:0xf
    v_and_b32_dpp v17, v22, v9 row_newbcast:13 row_mask:0xf bank_mask:0xf
    v_mfma_f32_16x16x32_bf16 v[18:21], v[10:13], v[168:171], v[18:21]
    v_and_b32_dpp v10, v22, v6 row_newbcast:3 row_mask:0xf bank_mask:0xf
    v_and_b32_dpp v11, v22, v7 row_newbcast:3 row_mask:0xf bank_mask:0xf
    v_and_b32_dpp v12, v22, v8 row_newbcast:3 row_mask:0xf bank_mask:0xf
    v_and_b32_dpp v13, v22, v9 row_newbcast:3 row_mask:0xf bank_mask:0xf
    v_mfma_f32_16x16x32_bf16 v[76:79], v[14:17], v[172:175], v[76:79]
    v_and_b32_dpp v14, v22, v6 row_newbcast:11 row_mask:0xf bank_mask:0xf
    v_and_b32_dpp v15, v22, v7 row_newbcast:11 row_mask:0xf bank_mask:0xf
    v_and_b32_dpp v16, v22, v8 row_newbcast:11 row_mask:0xf bank_mask:0xf
    v_and_b32_dpp v17, v22, v9 row_newbcast:11 row_mask:0xf bank_mask:0xf
    v_mfma_f32_16x16x32_bf16 v[18:21], v[10:13], v[176:179], v[18:21]
    v_and_b32_dpp v10, v22, v6 row_newbcast:7 row_mask:0xf bank_mask:0xf
    v_and_b32_dpp v11, v22, v7 row_newbcast:7 row_mask:0xf bank_mask:0xf
    v_and_b32_dpp v12, v22, v8 row_newbcast:7 row_mask:0xf bank_mask:0xf
    v_and_b32_dpp v13, v22, v9 row_newbcast:7 row_mask:0xf bank_mask:0xf
    v_mfma_f32_16x16x32_bf16 v[18:21], v[14:17], v[180:183], v[18:21]
    v_and_b32_dpp v14, v22, v6 row_newbcast:15 row_mask:0xf bank_mask:0xf
    v_and_b32_dpp v15, v22, v7 row_newbcast:15 row_mask:0xf bank_mask:0xf
    v_and_b32_dpp v16, v22, v8 row_newbcast:15 row_mask:0xf bank_mask:0xf
    v_and_b32_dpp v17, v22, v9 row_newbcast:15 row_mask:0xf bank_mask:0xf
    v_mfma_f32_16x16x32_bf16 v[18:21], v[10:13], v[184:187], v[18:21]
    v_and_b32_dpp v10, v23, v6 row_newbcast:0 row_mask:0xf bank_mask:0xf
    v_and_b32_dpp v11, v23, v7 row_newbcast:0 row_mask:0xf bank_mask:0xf
    v_and_b32_dpp v12, v23, v8 row_newbcast:0 row_mask:0xf bank_mask:0xf
    v_and_b32_dpp v13, v23, v9 row_newbcast:0 row_mask:0xf bank_mask:0xf
    v_mfma_f32_16x16x32_bf16 v[76:79], v[14:17], v[188:191], v[76:79]
    v_and_b32_dpp v14, v23, v6 row_newbcast:8 row_mask:0xf bank_mask:0xf
    v_and_b32_dpp v15, v23, v7 row_newbcast:8 row_mask:0xf bank_mask:0xf
    v_and_b32_dpp v16, v23, v8 row_newbcast:8 row_mask:0xf bank_mask:0xf
    v_and_b32_dpp v17, v23, v9 row_newbcast:8 row_mask:0xf bank_mask:0xf
    v_mfma_f32_16x16x32_bf16 v[18:21], v[10:13], v[192:195], v[18:21]
    v_and_b32_dpp v10, v23, v6 row_newbcast:4 row_mask:0xf bank_mask:0xf
    v_and_b32_dpp v11, v23, v7 row_newbcast:4 row_mask:0xf bank_mask:0xf
    v_and_b32_dpp v12, v23, v8 row_newbcast:4 row_mask:0xf bank_mask:0xf
    v_and_b32_dpp v13, v23, v9 row_newbcast:4 row_mask:0xf bank_mask:0xf
    v_mfma_f32_16x16x32_bf16 v[18:21], v[14:17], v[196:199], v[18:21]
    v_and_b32_dpp v14, v23, v6 row_newbcast:12 row_mask:0xf bank_mask:0xf
    v_and_b32_dpp v15, v23, v7 row_newbcast:12 row_mask:0xf bank_mask:0xf
    v_and_b32_dpp v16, v23, v8 row_newbcast:12 row_mask:0xf bank_mask:0xf
    v_and_b32_dpp v17, v23, v9 row_newbcast:12 row_mask:0xf bank_mask:0xf
    v_mfma_f32_16x16x32_bf16 v[18:21], v[10:13], v[200:203], v[18:21]
    v_and_b32_dpp v10, v23, v6 row_newbcast:2 row_mask:0xf bank_mask:0xf
    v_and_b32_dpp v11, v23, v7 row_newbcast:2 row_mask:0xf bank_mask:0xf
    v_and_b32_dpp v12, v23, v8 row_newbcast:2 row_mask:0xf bank_mask:0xf
    v_and_b32_dpp v13, v23, v9 row_newbcast:2 row_mask:0xf bank_mask:0xf
    v_mfma_f32_16x16x32_bf16 v[76:79], v[14:17], v[204:207], v[76:79]
    v_and_b32_dpp v14, v23, v6 row_newbcast:10 row_mask:0xf bank_mask:0xf
    v_and_b32_dpp v15, v23, v7 row_newbcast:10 row_mask:0xf bank_mask:0xf
    v_and_b32_dpp v16, v23, v8 row_newbcast:10 row_mask:0xf bank_mask:0xf
    v_and_b32_dpp v17, v23, v9 row_newbcast:10 row_mask:0xf bank_mask:0xf
    v_mfma_f32_16x16x32_bf16 v[18:21], v[10:13], v[208:211], v[18:21]
    v_and_b32_dpp v10, v23, v6 row_newbcast:6 row_mask:0xf bank_mask:0xf
    v_and_b32_dpp v11, v23, v7 row_newbcast:6 row_mask:0xf bank_mask:0xf
    v_and_b32_dpp v12, v23, v8 row_newbcast:6 row_mask:0xf bank_mask:0xf
    v_and_b32_dpp v13, v23, v9 row_newbcast:6 row_mask:0xf bank_mask:0xf
    v_mfma_f32_16x16x32_bf16 v[18:21], v[14:17], v[212:215], v[18:21]
    v_and_b32_dpp v14, v23, v6 row_newbcast:14 row_mask:0xf bank_mask:0xf
    v_and_b32_dpp v15, v23, v7 row_newbcast:14 row_mask:0xf bank_mask:0xf
    v_and_b32_dpp v16, v23, v8 row_newbcast:14 row_mask:0xf bank_mask:0xf
    v_and_b32_dpp v17, v23, v9 row_newbcast:14 row_mask:0xf bank_mask:0xf
    v_mfma_f32_16x16x32_bf16 v[18:21], v[10:13], v[216:219], v[18:21]
    s_waitcnt vmcnt(8)
    v_and_b32_dpp v10, v23, v6 row_newbcast:1 row_mask:0xf bank_mask:0xf
    v_and_b32_dpp v11, v23, v7 row_newbcast:1 row_mask:0xf bank_mask:0xf
    v_and_b32_dpp v12, v23, v8 row_newbcast:1 row_mask:0xf bank_mask:0xf
    v_and_b32_dpp v13, v23, v9 row_newbcast:1 row_mask:0xf bank_mask:0xf
    v_mfma_f32_16x16x32_bf16 v[76:79], v[14:17], v[220:223], v[76:79]
    s_waitcnt vmcnt(7)
    v_and_b32_dpp v14, v23, v6 row_newbcast:9 row_mask:0xf bank_mask:0xf
    v_and_b32_dpp v15, v23, v7 row_newbcast:9 row_mask:0xf bank_mask:0xf
    v_and_b32_dpp v16, v23, v8 row_newbcast:9 row_mask:0xf bank_mask:0xf
    v_and_b32_dpp v17, v23, v9 row_newbcast:9 row_mask:0xf bank_mask:0xf
    v_mfma_f32_16x16x32_bf16 v[18:21], v[10:13], v[224:227], v[18:21]
    s_waitcnt vmcnt(6)
    v_and_b32_dpp v10, v23, v6 row_newbcast:5 row_mask:0xf bank_mask:0xf
    v_and_b32_dpp v11, v23, v7 row_newbcast:5 row_mask:0xf bank_mask:0xf
    v_and_b32_dpp v12, v23, v8 row_newbcast:5 row_mask:0xf bank_mask:0xf
    v_and_b32_dpp v13, v23, v9 row_newbcast:5 row_mask:0xf bank_mask:0xf
    v_mfma_f32_16x16x32_bf16 v[18:21], v[14:17], v[228:231], v[18:21]
    s_waitcnt vmcnt(5)
    v_and_b32_dpp v14, v23, v6 row_newbcast:13 row_mask:0xf bank_mask:0xf
    v_and_b32_dpp v15, v23, v7 row_newbcast:13 row_mask:0xf bank_mask:0xf
    v_and_b32_dpp v16, v23, v8 row_newbcast:13 row_mask:0xf bank_mask:0xf
    v_and_b32_dpp v17, v23, v9 row_newbcast:13 row_mask:0xf bank_mask:0xf
    v_mfma_f32_16x16x32_bf16 v[18:21], v[10:13], v[232:235], v[18:21]
    s_waitcnt vmcnt(4)
    v_and_b32_dpp v10, v23, v6 row_newbcast:3 row_mask:0xf bank_mask:0xf
    v_and_b32_dpp v11, v23, v7 row_newbcast:3 row_mask:0xf bank_mask:0xf
    v_and_b32_dpp v12, v23, v8 row_newbcast:3 row_mask:0xf bank_mask:0xf
    v_and_b32_dpp v13, v23, v9 row_newbcast:3 row_mask:0xf bank_mask:0xf
    v_mfma_f32_16x16x32_bf16 v[76:79], v[14:17], v[236:239], v[76:79]
    s_waitcnt vmcnt(3)
    v_and_b32_dpp v14, v23, v6 row_newbcast:11 row_mask:0xf bank_mask:0xf
    v_and_b32_dpp v15, v23, v7 row_newbcast:11 row_mask:0xf bank_mask:0xf
    v_and_b32_dpp v16, v23, v8 row_newbcast:11 row_mask:0xf bank_mask:0xf
    v_and_b32_dpp v17, v23, v9 row_newbcast:11 row_mask:0xf bank_mask:0xf
    v_mfma_f32_16x16x32_bf16 v[18:21], v[10:13], v[240:243], v[18:21]
    s_waitcnt vmcnt(2)
    v_and_b32_dpp v10, v23, v6 row_newbcast:7 row_mask:0xf bank_mask:0xf
    v_and_b32_dpp v11, v23, v7 row_newbcast:7 row_mask:0xf bank_mask:0xf
    v_and_b32_dpp v12, v23, v8 row_newbcast:7 row_mask:0xf bank_mask:0xf
    v_and_b32_dpp v13, v23, v9 row_newbcast:7 row_mask:0xf bank_mask:0xf
    v_mfma_f32_16x16x32_bf16 v[18:21], v[14:17], v[244:247], v[18:21]
    s_waitcnt vmcnt(1)
    v_and_b32_dpp v14, v23, v6 row_newbcast:15 row_mask:0xf bank_mask:0xf
    v_and_b32_dpp v15, v23, v7 row_newbcast:15 row_mask:0xf bank_mask:0xf
    v_and_b32_dpp v16, v23, v8 row_newbcast:15 row_mask:0xf bank_mask:0xf
    v_and_b32_dpp v17, v23, v9 row_newbcast:15 row_mask:0xf bank_mask:0xf
    v_mfma_f32_16x16x32_bf16 v[18:21], v[10:13], v[248:251], v[18:21]
    s_waitcnt vmcnt(0)
    v_mfma_f32_16x16x32_bf16 v[76:79], v[14:17], v[252:255], v[76:79]
    s_cmp_eq_u32 s89, 1
    s_cbranch_scc1 L_h_b2
    s_mov_b32 exec_hi, 0
    s_nop 2
    v_mul_f32 v18, v42, v18
    v_mul_f32 v19, v42, v19
    v_mul_f32 v20, v42, v20
    v_mul_f32 v21, v42, v21
    v_fmac_f32 v18, v43, v76
    v_fmac_f32 v19, v43, v77
    v_fmac_f32 v20, v43, v78
    v_fmac_f32 v21, v43, v79
    ds_write_b128 v40, v[18:21] offset:4096
    s_waitcnt lgkmcnt(0)
    s_barrier
    s_endpgm
L_tonear:
    s_mov_b64 s[48:49], s[60:61]
    s_mov_b64 s[50:51], s[62:63]
    s_mov_b64 s[12:13], s[4:5]
    s_mov_b64 s[14:15], s[6:7]
    v_mov_b32 v54, v57
    v_add_u32 v55, s52, v57
    v_bfi_b32 v1, s52, v1, v57
    v_mov_b32 v59, 4
    s_branch L_tonear_back
L_swap:
    s_mov_b32 s45, 16777216
L_waitx:
    ds_read_b32 v58, v53 offset:2184
    ds_read2st64_b32 v[64:65], v60 offset0:24 offset1:25
    s_waitcnt lgkmcnt(0)
    v_readfirstlane_b32 s64, v58
    s_nop 0
    s_cmp_eq_u32 s64, 0
    s_cbranch_scc1 L_gotx
    s_sub_u32 s45, s45, 1
    s_cbranch_scc0 L_waitx
L_gotx:
    s_mov_b32 s64, 0x01000100
    s_mov_b32 s45, 0x03020302
    v_perm_b32 v66, v64, v64, s64
    v_perm_b32 v67, v64, v64, s45
    v_perm_b32 v68, v65, v65, s64
    v_perm_b32 v69, v65, v65, s45
    v_pk_add_f32 v[18:19], v[18:19], v[76:77]
    v_pk_add_f32 v[20:21], v[20:21], v[78:79]
    v_mov_b64 v[76:77], 0
    v_mov_b64 v[78:79], 0
    v_mov_b32_dpp v23, v67 row_shr:8 row_mask:0xf bank_mask:0x8
    v_mov_b32_dpp v24, v66 row_shr:4 row_mask:0xf bank_mask:0x8
    v_mov_b32_dpp v25, v67 row_shr:4 row_mask:0xf bank_mask:0x8
    v_mov_b32_dpp v26, v66 quad_perm:[0,1,2,3] row_mask:0xf bank_mask:0x8
    v_mov_b32_dpp v27, v67 quad_perm:[0,1,2,3] row_mask:0xf bank_mask:0x8
    v_mov_b32_dpp v28, v68 row_shr:12 row_mask:0xf bank_mask:0x8
    v_mov_b32_dpp v29, v69 row_shr:12 row_mask:0xf bank_mask:0x8
    v_mov_b32_dpp v30, v68 row_shr:8 row_mask:0xf bank_mask:0x8
    v_mov_b32_dpp v31, v69 row_shr:8 row_mask:0xf bank_mask:0x8
    v_mov_b32_dpp v32, v68 row_shr:4 row_mask:0xf bank_mask:0x8
    v_mov_b32_dpp v33, v69 row_shr:4 row_mask:0xf bank_mask:0x8
    v_mov_b32_dpp v34, v68 quad_perm:[0,1,2,3] row_mask:0xf bank_mask:0x8
    v_mov_b32_dpp v35, v69 quad_perm:[0,1,2,3] row_mask:0xf bank_mask:0x8
    s_branch L_swap_back
.p2align 6
L_h_q:
    s_bfe_u32 s26, s2, 0x10006
    s_bfe_u32 s27, s2, 0x10002
    s_lshl1_add_u32 s27, s26, s27
    s_lshr_b32 s28, s2, 7
    s_and_b32 s29, s2, 3
    s_and_b32 s30, s25, 7
    s_lshl3_add_u32 s29, s29, s30
    s_lshl_b32 s30, s28, 5
    s_add_u32 s30, s30, s29
    v_and_b32 v0, 63, v0
    s_lshl2_add_u32 s31, s30, s27
    s_lshl2_add_u32 s37, s28, s27
    s_sub_u32 s33, s3, 4
    v_lshrrev_b32 v1, 4, v0
    v_and_b32 v2, 15, v0
    s_getreg_b32 s32, hwreg(HW_REG_XCC_ID, 2, 1)
    v_lshl_add_u32 v3, v2, 2, v1
    v_lshlrev_b32 v3, 2, v3
    s_mul_i32 s34, s37, 160
    v_lshlrev_b32 v4, 13, v1
    v_lshl_add_u32 v4, v2, 4, v4
    s_lshl_b32 s35, s29, 8
    s_mul_i32 s36, s37, 655360
    s_add_u32 s35, s35, s36
    s_movk_i32 s46, 2560
    s_mov_b32 s47, 0x20000
    s_mov_b32 s42, 647424
    s_mov_b32 s43, 0x20000
    s_mov_b32 s48, 0
    s_mov_b32 s49, 0x8000
    s_waitcnt lgkmcnt(0)
    s_mov_b64 s[44:45], s[4:5]
    s_add_u32 s40, s10, s35
    s_addc_u32 s41, s11, 0
    s_load_dwordx2 s[56:57], s[18:19], 12288
    buffer_load_dword v22, v3, s[44:47], s34 offen offset:0
    buffer_load_dword v23, v3, s[44:47], s34 offen offset:1280
    buffer_load_dwordx4 v[96:99], v4, s[40:43], s48 offen
    s_add_u32 s48, s48, s49
    buffer_load_dwordx4 v[100:103], v4, s[40:43], s48 offen
    s_add_u32 s48, s48, s49
    buffer_load_dwordx4 v[104:107], v4, s[40:43], s48 offen
    s_add_u32 s48, s48, s49
    buffer_load_dwordx4 v[108:111], v4, s[40:43], s48 offen
    s_add_u32 s48, s48, s49
    buffer_load_dwordx4 v[112:115], v4, s[40:43], s48 offen
    s_add_u32 s48, s48, s49
    buffer_load_dwordx4 v[116:119], v4, s[40:43], s48 offen
    s_add_u32 s48, s48, s49
    buffer_load_dwordx4 v[120:123], v4, s[40:43], s48 offen
    s_add_u32 s48, s48, s49
    buffer_load_dwordx4 v[124:127], v4, s[40:43], s48 offen
    s_add_u32 s48, s48, s49
    buffer_load_dwordx4 v[128:131], v4, s[40:43], s48 offen
    s_add_u32 s48, s48, s49
    buffer_load_dwordx4 v[132:135], v4, s[40:43], s48 offen
    s_add_u32 s48, s48, s49
    buffer_load_dwordx4 v[136:139], v4, s[40:43], s48 offen
    s_add_u32 s48, s48, s49
    buffer_load_dwordx4 v[140:143], v4, s[40:43], s48 offen
    s_add_u32 s48, s48, s49
    buffer_load_dwordx4 v[144:147], v4, s[40:43], s48 offen
    s_add_u32 s48, s48, s49
    buffer_load_dwordx4 v[148:151], v4, s[40:43], s48 offen
    s_add_u32 s48, s48, s49
    buffer_load_dwordx4 v[152:155], v4, s[40:43], s48 offen
    s_add_u32 s48, s48, s49
    buffer_load_dwordx4 v[156:159], v4, s[40:43], s48 offen
    s_add_u32 s48, s48, s49
    buffer_load_dwordx4 v[160:163], v4, s[40:43], s48 offen
    s_add_u32 s48, s48, s49
    buffer_load_dwordx4 v[164:167], v4, s[40:43], s48 offen
    s_add_u32 s48, s48, s49
    buffer_load_dwordx4 v[168:171], v4, s[40:43], s48 offen
    s_add_u32 s48, s48, s49
    buffer_load_dwordx4 v[172:175], v4, s[40:43], s48 offen
    s_barrier
    v_and_b32 v5, 16, v0
    v_lshl_add_u32 v5, v2, 5, v5
    v_lshlrev_b32 v27, 3, v0
    v_mov_b32 v35, 0
    v_and_b32 v58, 3, v0
    v_mul_u32_u24 v58, 0x5555, v58
    v_mov_b64 v[176:177], 0
    v_mov_b64 v[178:179], 0
    v_mov_b64 v[180:181], 0
    v_mov_b64 v[182:183], 0
    v_mov_b64 v[184:185], 0
    v_mov_b64 v[186:187], 0
    v_mov_b64 v[188:189], 0
    v_mov_b64 v[190:191], 0
    v_mov_b64 v[192:193], 0
    v_mov_b64 v[194:195], 0
    v_mov_b64 v[196:197], 0
    v_mov_b64 v[198:199], 0
    v_mov_b64 v[200:201], 0
    v_mov_b64 v[202:203], 0
    v_mov_b64 v[204:205], 0
    v_mov_b64 v[206:207], 0
    v_mov_b64 v[208:209], 0
    v_mov_b64 v[210:211], 0
    v_mov_b64 v[212:213], 0
    v_mov_b64 v[214:215], 0
    v_mov_b64 v[18:19], 0
    v_mov_b64 v[20:21], 0
    s_lshl3_add_u32 s50, s29, s37
    s_lshl_b32 s50, s50, 9
    s_add_u32 s50, s50, 589824
    v_and_b32 v26, 31, v0
    v_lshl_add_u32 v26, v26, 4, s50
    v_lshrrev_b32 v34, 5, v0
    v_lshl_add_u32 v26, v34, 17, v26
    s_lshl_b32 s50, s30, 12
    s_add_u32 s50, s50, 589824
    v_lshl_add_u32 v32, v0, 4, s50
    v_lshrrev_b32 v33, 1, v5
    v_lshl_add_u32 v33, v34, 2, v33
    s_waitcnt lgkmcnt(0)
    s_and_b32 s50, s56, 0x80808080
    s_and_b32 s56, s56, 0x7f7f7f7f
    s_add_u32 s56, s56, 0x2b1d1107
    s_xor_b32 s56, s56, s50
    s_mul_i32 s57, s57, 22695477
    s_add_u32 s57, s57, 0x9e3779b1
    s_bfe_u32 s60, s56, 0x80000
    s_bfe_u32 s61, s56, 0x80008
    s_bfe_u32 s62, s56, 0x80010
    s_bfe_u32 s63, s56, 0x80018
    s_lshl_b32 s50, s32, 7
    s_xor_b32 s50, s50, s63
    v_mov_b32 v64, s60
    v_mov_b32 v65, s61
    v_mov_b32 v66, s62
    v_mov_b32 v67, s50
    s_movk_i32 s51, 0xff00
    s_waitcnt vmcnt(20)
    v_lshrrev_b32 v24, 16, v22
    v_lshrrev_b32 v25, 16, v23
    v_and_b32 v22, 0xffff, v22
    v_and_b32 v23, 0xffff, v23
    s_nop 0
    v_mov_b32_dpp v176, v22 row_newbcast:0 row_mask:0xf bank_mask:1
    v_mov_b32_dpp v176, v23 row_newbcast:0 row_mask:0xf bank_mask:4
    v_mov_b32_dpp v177, v22 row_newbcast:0 row_mask:0xf bank_mask:2
    v_mov_b32_dpp v177, v23 row_newbcast:0 row_mask:0xf bank_mask:8
    v_mov_b32_dpp v178, v24 row_newbcast:0 row_mask:0xf bank_mask:1
    v_mov_b32_dpp v178, v25 row_newbcast:0 row_mask:0xf bank_mask:4
    v_mov_b32_dpp v179, v24 row_newbcast:0 row_mask:0xf bank_mask:2
    v_mov_b32_dpp v179, v25 row_newbcast:0 row_mask:0xf bank_mask:8
    v_mov_b32_dpp v180, v22 row_newbcast:1 row_mask:0xf bank_mask:1
    v_mov_b32_dpp v180, v23 row_newbcast:1 row_mask:0xf bank_mask:4
    v_mov_b32_dpp v181, v22 row_newbcast:1 row_mask:0xf bank_mask:2
    v_mov_b32_dpp v181, v23 row_newbcast:1 row_mask:0xf bank_mask:8
    v_mov_b32_dpp v182, v24 row_newbcast:1 row_mask:0xf bank_mask:1
    v_mov_b32_dpp v182, v25 row_newbcast:1 row_mask:0xf bank_mask:4
    v_mov_b32_dpp v183, v24 row_newbcast:1 row_mask:0xf bank_mask:2
    v_mov_b32_dpp v183, v25 row_newbcast:1 row_mask:0xf bank_mask:8
    v_mov_b32_dpp v184, v22 row_newbcast:2 row_mask:0xf bank_mask:1
    v_mov_b32_dpp v184, v23 row_newbcast:2 row_mask:0xf bank_mask:4
    v_mov_b32_dpp v185, v22 row_newbcast:2 row_mask:0xf bank_mask:2
    v_mov_b32_dpp v185, v23 row_newbcast:2 row_mask:0xf bank_mask:8
    v_mov_b32_dpp v186, v24 row_newbcast:2 row_mask:0xf bank_mask:1
    v_mov_b32_dpp v186, v25 row_newbcast:2 row_mask:0xf bank_mask:4
    v_mov_b32_dpp v187, v24 row_newbcast:2 row_mask:0xf bank_mask:2
    v_mov_b32_dpp v187, v25 row_newbcast:2 row_mask:0xf bank_mask:8
    v_mov_b32_dpp v188, v22 row_newbcast:3 row_mask:0xf bank_mask:1
    v_mov_b32_dpp v188, v23 row_newbcast:3 row_mask:0xf bank_mask:4
    v_mov_b32_dpp v189, v22 row_newbcast:3 row_mask:0xf bank_mask:2
    v_mov_b32_dpp v189, v23 row_newbcast:3 row_mask:0xf bank_mask:8
    v_mov_b32_dpp v190, v24 row_newbcast:3 row_mask:0xf bank_mask:1
    v_mov_b32_dpp v190, v25 row_newbcast:3 row_mask:0xf bank_mask:4
    v_mov_b32_dpp v191, v24 row_newbcast:3 row_mask:0xf bank_mask:2
    v_mov_b32_dpp v191, v25 row_newbcast:3 row_mask:0xf bank_mask:8
    v_mov_b32_dpp v192, v22 row_newbcast:4 row_mask:0xf bank_mask:1
    v_mov_b32_dpp v192, v23 row_newbcast:4 row_mask:0xf bank_mask:4
    v_mov_b32_dpp v193, v22 row_newbcast:4 row_mask:0xf bank_mask:2
    v_mov_b32_dpp v193, v23 row_newbcast:4 row_mask:0xf bank_mask:8
    v_mov_b32_dpp v194, v24 row_newbcast:4 row_mask:0xf bank_mask:1
    v_mov_b32_dpp v194, v25 row_newbcast:4 row_mask:0xf bank_mask:4
    v_mov_b32_dpp v195, v24 row_newbcast:4 row_mask:0xf bank_mask:2
    v_mov_b32_dpp v195, v25 row_newbcast:4 row_mask:0xf bank_mask:8
    v_mov_b32_dpp v196, v22 row_newbcast:5 row_mask:0xf bank_mask:1
    v_mov_b32_dpp v196, v23 row_newbcast:5 row_mask:0xf bank_mask:4
    v_mov_b32_dpp v197, v22 row_newbcast:5 row_mask:0xf bank_mask:2
    v_mov_b32_dpp v197, v23 row_newbcast:5 row_mask:0xf bank_mask:8
    v_mov_b32_dpp v198, v24 row_newbcast:5 row_mask:0xf bank_mask:1
    v_mov_b32_dpp v198, v25 row_newbcast:5 row_mask:0xf bank_mask:4
    v_mov_b32_dpp v199, v24 row_newbcast:5 row_mask:0xf bank_mask:2
    v_mov_b32_dpp v199, v25 row_newbcast:5 row_mask:0xf bank_mask:8
    v_mov_b32_dpp v200, v22 row_newbcast:6 row_mask:0xf bank_mask:1
    v_mov_b32_dpp v200, v23 row_newbcast:6 row_mask:0xf bank_mask:4
    v_mov_b32_dpp v201, v22 row_newbcast:6 row_mask:0xf bank_mask:2
    v_mov_b32_dpp v201, v23 row_newbcast:6 row_mask:0xf bank_mask:8
    v_mov_b32_dpp v202, v24 row_newbcast:6 row_mask:0xf bank_mask:1
    v_mov_b32_dpp v202, v25 row_newbcast:6 row_mask:0xf bank_mask:4
    v_mov_b32_dpp v203, v24 row_newbcast:6 row_mask:0xf bank_mask:2
    v_mov_b32_dpp v203, v25 row_newbcast:6 row_mask:0xf bank_mask:8
    v_mov_b32_dpp v204, v22 row_newbcast:7 row_mask:0xf bank_mask:1
    v_mov_b32_dpp v204, v23 row_newbcast:7 row_mask:0xf bank_mask:4
    v_mov_b32_dpp v205, v22 row_newbcast:7 row_mask:0xf bank_mask:2
    v_mov_b32_dpp v205, v23 row_newbcast:7 row_mask:0xf bank_mask:8
    v_mov_b32_dpp v206, v24 row_newbcast:7 row_mask:0xf bank_mask:1
    v_mov_b32_dpp v206, v25 row_newbcast:7 row_mask:0xf bank_mask:4
    v_mov_b32_dpp v207, v24 row_newbcast:7 row_mask:0xf bank_mask:2
    v_mov_b32_dpp v207, v25 row_newbcast:7 row_mask:0xf bank_mask:8
    v_mov_b32_dpp v208, v22 row_newbcast:8 row_mask:0xf bank_mask:1
    v_mov_b32_dpp v208, v23 row_newbcast:8 row_mask:0xf bank_mask:4
    v_mov_b32_dpp v209, v22 row_newbcast:8 row_mask:0xf bank_mask:2
    v_mov_b32_dpp v209, v23 row_newbcast:8 row_mask:0xf bank_mask:8
    v_mov_b32_dpp v210, v24 row_newbcast:8 row_mask:0xf bank_mask:1
    v_mov_b32_dpp v210, v25 row_newbcast:8 row_mask:0xf bank_mask:4
    v_mov_b32_dpp v211, v24 row_newbcast:8 row_mask:0xf bank_mask:2
    v_mov_b32_dpp v211, v25 row_newbcast:8 row_mask:0xf bank_mask:8
    v_mov_b32_dpp v212, v22 row_newbcast:9 row_mask:0xf bank_mask:1
    v_mov_b32_dpp v212, v23 row_newbcast:9 row_mask:0xf bank_mask:4
    v_mov_b32_dpp v213, v22 row_newbcast:9 row_mask:0xf bank_mask:2
    v_mov_b32_dpp v213, v23 row_newbcast:9 row_mask:0xf bank_mask:8
    v_mov_b32_dpp v214, v24 row_newbcast:9 row_mask:0xf bank_mask:1
    v_mov_b32_dpp v214, v25 row_newbcast:9 row_mask:0xf bank_mask:4
    v_mov_b32_dpp v215, v24 row_newbcast:9 row_mask:0xf bank_mask:2
    v_mov_b32_dpp v215, v25 row_newbcast:9 row_mask:0xf bank_mask:8
    s_waitcnt vmcnt(18)
    v_smfmac_f32_16x16x64_bf16 v[18:21], v[176:179], v[96:103], v58
    s_waitcnt vmcnt(16)
    v_smfmac_f32_16x16x64_bf16 v[18:21], v[180:183], v[104:111], v58
    s_waitcnt vmcnt(14)
    v_smfmac_f32_16x16x64_bf16 v[18:21], v[184:187], v[112:119], v58
    s_waitcnt vmcnt(12)
    v_smfmac_f32_16x16x64_bf16 v[18:21], v[188:191], v[120:127], v58
    s_waitcnt vmcnt(10)
    v_smfmac_f32_16x16x64_bf16 v[18:21], v[192:195], v[128:135], v58
    s_waitcnt vmcnt(8)
    v_smfmac_f32_16x16x64_bf16 v[18:21], v[196:199], v[136:143], v58
    s_waitcnt vmcnt(6)
    v_smfmac_f32_16x16x64_bf16 v[18:21], v[200:203], v[144:151], v58
    s_waitcnt vmcnt(4)
    v_smfmac_f32_16x16x64_bf16 v[18:21], v[204:207], v[152:159], v58
    s_waitcnt vmcnt(2)
    v_smfmac_f32_16x16x64_bf16 v[18:21], v[208:211], v[160:167], v58
    s_waitcnt vmcnt(0)
    v_smfmac_f32_16x16x64_bf16 v[18:21], v[212:215], v[168:175], v58
    s_nop 7
    v_add_u32 v18, 0x80, v18
    v_add_u32 v19, 0x80, v19
    v_add_u32 v20, 0x80, v20
    v_add_u32 v21, 0x80, v21
    v_and_or_b32 v64, v18, s51, v64
    v_and_or_b32 v65, v19, s51, v65
    v_and_or_b32 v66, v20, s51, v66
    v_and_or_b32 v67, v21, s51, v67
    global_store_dwordx4 v26, v[64:67], s[18:19] sc1
    s_waitcnt vmcnt(0)
    s_mov_b32 s50, 1048576
L_h_pollq:
    global_load_dwordx4 v[96:99], v32, s[18:19] offset:0 sc1
    global_load_dwordx4 v[100:103], v32, s[18:19] offset:1024 sc1
    global_load_dwordx4 v[104:107], v32, s[18:19] offset:2048 sc1
    global_load_dwordx4 v[108:111], v32, s[18:19] offset:3072 sc1
    s_waitcnt vmcnt(0)
    v_xor_b32 v96, s60, v96
    v_xor_b32 v97, s61, v97
    v_xor_b32 v98, s62, v98
    v_xor_b32 v99, s63, v99
    v_xor_b32 v100, s60, v100
    v_xor_b32 v101, s61, v101
    v_xor_b32 v102, s62, v102
    v_xor_b32 v103, s63, v103
    v_xor_b32 v104, s60, v104
    v_xor_b32 v105, s61, v105
    v_xor_b32 v106, s62, v106
    v_xor_b32 v107, s63, v107
    v_xor_b32 v108, s60, v108
    v_xor_b32 v109, s61, v109
    v_xor_b32 v110, s62, v110
    v_xor_b32 v111, s63, v111
    v_or3_b32 v72, v99, v103, v107
    v_or_b32 v72, v72, v111
    v_and_b32 v72, 0x7f, v72
    v_or3_b32 v73, v96, v97, v98
    v_or_b32 v72, v72, v73
    v_or3_b32 v73, v100, v101, v102
    v_or_b32 v72, v72, v73
    v_or3_b32 v73, v104, v105, v106
    v_or_b32 v72, v72, v73
    v_or3_b32 v73, v108, v109, v110
    v_or_b32 v72, v72, v73
    v_and_b32 v72, 0xff, v72
    v_cmp_ne_u32 vcc, 0, v72
    s_nop 0
    s_cbranch_vccz L_h_gotq
    s_sub_u32 s50, s50, 1
    s_cbranch_scc0 L_h_pollq
L_h_gotq:
    v_lshlrev_b32 v74, 24, v99
    v_and_b32 v99, s51, v99
    v_lshlrev_b32 v75, 24, v103
    v_and_b32 v103, s51, v103
    v_lshlrev_b32 v76, 24, v107
    v_and_b32 v107, s51, v107
    v_lshlrev_b32 v77, 24, v111
    v_and_b32 v111, s51, v111
    v_pk_add_f32 v[96:97], v[96:97], v[100:101]
    v_pk_add_f32 v[104:105], v[104:105], v[108:109]
    v_pk_add_f32 v[98:99], v[98:99], v[102:103]
    v_pk_add_f32 v[106:107], v[106:107], v[110:111]
    v_pk_add_f32 v[96:97], v[96:97], v[104:105]
    v_pk_add_f32 v[98:99], v[98:99], v[106:107]
    s_nop 1
    v_permlane32_swap_b32 v96, v98
    v_permlane32_swap_b32 v97, v99
    v_pk_add_f32 v[96:97], v[96:97], v[98:99]
    v_cvt_pk_bf16_f32 v72, v96, v97
    ds_write_b32 v33, v72 offset:0
    ds_write_b32 v35, v35 offset:2176
    v_readlane_b32 s52, v74, 0
    v_readlane_b32 s60, v74, 32
    v_readlane_b32 s53, v75, 0
    v_readlane_b32 s61, v75, 32
    v_readlane_b32 s54, v76, 0
    v_readlane_b32 s62, v76, 32
    v_readlane_b32 s55, v77, 0
    v_readlane_b32 s63, v77, 32
    s_xor_b64 s[52:53], s[52:53], s[60:61]
    s_xor_b64 s[54:55], s[54:55], s[62:63]
    s_cmp_eq_u32 s28, 0
    s_cselect_b64 s[54:55], s[52:53], s[54:55]
    s_cmp_eq_u32 s26, 0
    s_cselect_b32 s55, s54, s55
    s_mov_b64 exec, 1
    s_mov_b32 s50, 1048576
L_wp2127:
    ds_read_b32 v41, v35 offset:2188
    s_waitcnt lgkmcnt(0)
    v_cmp_gt_i32 vcc, 4, v41
    s_nop 0
    s_cbranch_vccz L_wpd2127
    s_sleep 1
    s_sub_u32 s50, s50, 1
    s_cbranch_scc0 L_wp2127
L_wpd2127:
    s_load_dword s58, s[16:17], 128
    s_waitcnt lgkmcnt(0)
    s_cmp_ge_u32 s58, 0x300
    s_cbranch_scc1 L_d_got
    s_mov_b32 s50, 1048576
L_d_poll:
    global_load_dword v37, v35, s[16:17] offset:128 sc1
    s_waitcnt vmcnt(0)
    v_readfirstlane_b32 s58, v37
    s_nop 0
    s_cmp_ge_u32 s58, 0x300
    s_cbranch_scc1 L_d_got
    s_sleep 16
    s_sub_u32 s50, s50, 1
    s_cbranch_scc0 L_d_poll
L_d_got:
    s_xor_b32 s60, s32, s26
    s_lshl_b32 s60, s60, 13
    s_or_b32 s60, s60, 1
    s_xor_b32 s61, s60, 0x2000
    s_cmp_eq_u32 s58, 0x305
    s_cselect_b32 s62, s60, 0
    s_cmp_eq_u32 s58, 0x30a
    s_cselect_b32 s62, s61, s62
    s_or_b32 s60, s60, 2
    s_or_b32 s61, s61, 2
    s_cmp_eq_u32 s58, 0x309
    s_cselect_b32 s62, s60, s62
    s_cmp_eq_u32 s58, 0x306
    s_cselect_b32 s62, s61, s62
    s_cmp_lt_i32 s55, 0
    s_cselect_b32 s62, s62, 0
    s_mov_b32 s60, 41
    s_bitcmp1_b32 s62, 1
    s_cselect_b32 s60, 0, s60
    s_cselect_b32 s61, 0, -3
    v_mov_b32 v36, s60
    v_mov_b32 v37, s62
    ds_write_b32 v35, v36 offset:516
    ds_write_b32 v35, v37 offset:2180
    s_mov_b64 exec, -1
    s_branch L_h_wq2
.p2align 6
L_h_other:
    s_barrier
    s_bfe_u32 s26, s2, 0x10006
    s_bfe_u32 s27, s2, 0x10002
    s_lshl1_add_u32 s27, s26, s27
    s_lshr_b32 s28, s2, 7
    s_and_b32 s29, s2, 3
    s_and_b32 s30, s25, 7
    s_lshl3_add_u32 s29, s29, s30
    s_lshl_b32 s30, s28, 5
    s_add_u32 s30, s30, s29
    v_and_b32 v0, 63, v0
    s_lshl2_add_u32 s31, s30, s27
    s_lshl2_add_u32 s37, s28, s27
    s_sub_u32 s33, s3, 4
    v_lshrrev_b32 v1, 4, v0
    v_and_b32 v2, 15, v0
    s_getreg_b32 s32, hwreg(HW_REG_XCC_ID, 2, 1)
    v_lshlrev_b32 v32, 4, v0
    v_mov_b64 v[28:29], -1
    v_mov_b64 v[30:31], -1
    s_waitcnt lgkmcnt(0)
    s_lshl2_add_u32 s36, s29, s33
    s_mul_i32 s35, s36, 40960
    s_add_u32 s40, s12, s35
    s_addc_u32 s41, s13, 0
    s_mov_b32 s42, 40960
    s_mov_b32 s43, 0x20000
    v_mul_u32_u24 v4, 1280, v1
    v_lshl_add_u32 v4, v2, 4, v4
    s_mul_i32 s48, s37, 5120
    buffer_load_dwordx4 v[96:99], v4, s[40:43], s48 offen offset:0
    buffer_load_dwordx4 v[104:107], v4, s[40:43], s48 offen offset:256
    buffer_load_dwordx4 v[112:115], v4, s[40:43], s48 offen offset:512
    buffer_load_dwordx4 v[120:123], v4, s[40:43], s48 offen offset:768
    buffer_load_dwordx4 v[128:131], v4, s[40:43], s48 offen offset:1024
    s_cmp_lg_u32 s33, 1
    s_cbranch_scc1 L_h_not1
    s_sub_u32 s40, s40, 40960
    s_subb_u32 s41, s41, 0
    buffer_load_dwordx4 v[64:67], v4, s[40:43], s48 offen offset:0
    buffer_load_dwordx4 v[68:71], v4, s[40:43], s48 offen offset:256
    buffer_load_dwordx4 v[72:75], v4, s[40:43], s48 offen offset:512
    buffer_load_dwordx4 v[76:79], v4, s[40:43], s48 offen offset:768
    buffer_load_dwordx4 v[80:83], v4, s[40:43], s48 offen offset:1024
    s_load_dwordx2 s[56:57], s[18:19], 12288
    s_and_b32 s35, s31, 0xf8
    s_add_u32 s35, s35, s31
    s_lshl_b32 s35, s35, 10
    s_add_u32 s35, s35, 65536
    s_add_u32 s44, s18, s35
    s_addc_u32 s45, s19, 0
    s_movk_i32 s46, 8832
    s_mov_b32 s47, 0x20000
    s_movk_i32 s49, 8192
    s_mov_b32 exec_hi, 0xff
    buffer_store_dwordx4 v[28:31], v32, s[44:47], 0 offen sc1
    buffer_store_dwordx4 v[28:31], v32, s[44:47], s49 offen sc1
    s_mov_b64 exec, -1
    s_waitcnt lgkmcnt(0)
    s_and_b32 s50, s56, 0x80808080
    s_and_b32 s56, s56, 0x7f7f7f7f
    s_add_u32 s56, s56, 0x2b1d1107
    s_xor_b32 s56, s56, s50
    s_mul_i32 s57, s57, 22695477
    s_add_u32 s57, s57, 0x9e3779b1
    s_cmp_lg_u32 s2, 0
    s_cbranch_scc1 L_h_wq
    s_mov_b32 s54, 0
    s_atomic_swap s54, s[18:19], 917504
    s_atomic_swap s54, s[18:19], 921856
    s_atomic_swap s54, s[18:19], 926208
    s_atomic_swap s54, s[18:19], 930560
    s_movk_i32 s55, 0x100
    s_waitcnt lgkmcnt(0)
    s_atomic_add s55, s[16:17], 128
    s_waitcnt lgkmcnt(0)
    s_branch L_h_wq
L_h_not1:
    s_xor_b32 s53, s30, s27
    s_xor_b32 s53, s53, s33
    s_and_b32 s53, s53, 3
    s_cbranch_scc1 L_h_wq
    s_cmp_eq_u32 s33, 2
    s_cselect_b64 s[64:65], s[6:7], s[8:9]
    s_cselect_b32 s53, 0, 64
    s_lshr_b32 s66, s31, 1
    s_lshl_b32 s66, s66, 21
    s_add_u32 s64, s64, s66
    s_addc_u32 s65, s65, 0
    s_mov_b32 s68, 0
    s_bfe_u32 s70, s2, 0x10005
    s_lshl_b32 s70, s70, 13
    s_memtime s[72:73]
    s_waitcnt lgkmcnt(0)
    s_mul_i32 s67, s72, 0x9e3779b1
    s_lshr_b32 s67, s67, 11
L_p_loop:
    s_mov_b32 s76, s74
    s_add_u32 s67, s67, 0x6d2b80
    s_and_b32 s69, s67, 0x1fdf80
    s_or_b32 s69, s69, s70
    s_xor_b32 s70, s70, 0x2000
    s_memtime s[72:73]
    s_waitcnt lgkmcnt(0)
    s_load_dword s71, s[64:65], s69
    s_waitcnt lgkmcnt(0)
    s_memtime s[74:75]
    s_waitcnt lgkmcnt(0)
    s_sub_u32 s74, s74, s72
    s_add_u32 s68, s68, 1
    s_cmp_lt_u32 s68, 3
    s_cbranch_scc1 L_p_loop
    s_sub_u32 s76, s76, s74
    s_min_i32 s76, s76, 500
    s_max_i32 s76, s76, -500
    s_xor_b32 s77, s32, s26
    s_lshl_b32 s77, s77, 13
    s_cmp_eq_u32 s77, s70
    s_cselect_b32 s77, -1, 1
    s_mul_i32 s76, s76, s77
    s_add_u32 s76, s76, 16777716
    s_mov_b32 s77, s76
    s_atomic_add s76, s[16:17], s53 glc
    s_waitcnt lgkmcnt(0)
    s_add_u32 s76, s76, s77
    s_lshr_b32 s77, s76, 24
    s_cmp_lg_u32 s77, 56
    s_cbranch_scc1 L_h_wq
    s_sub_u32 s76, s76, 0x38006d60
    s_cmp_gt_i32 s76, 3080
    s_cselect_b32 s77, 1, 0
    s_cmp_lt_i32 s76, -3080
    s_cselect_b32 s77, 2, s77
    s_lshr_b32 s53, s53, 5
    s_lshl_b32 s77, s77, s53
    s_add_u32 s77, s77, 0x100
    s_atomic_add s77, s[16:17], 128
    s_waitcnt lgkmcnt(0)
L_h_wq:
    v_and_b32 v5, 16, v0
    v_lshl_add_u32 v5, v2, 5, v5
    v_lshlrev_b32 v27, 3, v0
    v_mov_b32 v35, 0
    v_and_b32 v58, 3, v0
    v_mul_u32_u24 v58, 0x5555, v58
L_h_wq2:
    s_mov_b32 s50, 1048576
L_wp2329:
    ds_read_b32 v41, v35 offset:2112
    s_waitcnt lgkmcnt(0)
    v_cmp_gt_i32 vcc, 2, v41
    s_nop 0
    s_cbranch_vccz L_wpd2329
    s_sleep 2
    s_sub_u32 s50, s50, 1
    s_cbranch_scc0 L_wp2329
L_wpd2329:
    s_and_b32 s35, s31, 0xf8
    s_add_u32 s35, s35, s31
    s_lshl_b32 s35, s35, 10
    s_add_u32 s35, s35, 65536
    s_add_u32 s44, s18, s35
    s_addc_u32 s45, s19, 0
    s_movk_i32 s46, 8832
    s_mov_b32 s47, 0x20000
    s_lshl2_add_u32 s36, s29, s33
    s_mul_i32 s35, s36, 40960
    s_add_u32 s40, s12, s35
    s_addc_u32 s41, s13, 0
    s_mov_b32 s42, 40960
    s_mov_b32 s43, 0x20000
    v_mul_u32_u24 v4, 1280, v1
    v_lshl_add_u32 v4, v2, 4, v4
    s_mul_i32 s48, s37, 5120
    s_mov_b32 s38, s37
    s_cmp_lg_u32 s33, 0
    s_cbranch_scc1 L_h_have0
    buffer_load_dwordx4 v[96:99], v4, s[40:43], s48 offen offset:0
    buffer_load_dwordx4 v[104:107], v4, s[40:43], s48 offen offset:256
    buffer_load_dwordx4 v[112:115], v4, s[40:43], s48 offen offset:512
    buffer_load_dwordx4 v[120:123], v4, s[40:43], s48 offen offset:768
    buffer_load_dwordx4 v[128:131], v4, s[40:43], s48 offen offset:1024
L_h_have0:
    s_add_u32 s38, s38, 1
    s_and_b32 s38, s38, 7
    s_mul_i32 s48, s38, 5120
    s_waitcnt vmcnt(0)
    buffer_load_dwordx4 v[100:103], v4, s[40:43], s48 offen offset:0
    buffer_load_dwordx4 v[108:111], v4, s[40:43], s48 offen offset:256
    s_waitcnt vmcnt(1)
    buffer_load_dwordx4 v[116:119], v4, s[40:43], s48 offen offset:512
    s_waitcnt vmcnt(1)
    buffer_load_dwordx4 v[124:127], v4, s[40:43], s48 offen offset:768
    s_waitcnt vmcnt(1)
    buffer_load_dwordx4 v[132:135], v4, s[40:43], s48 offen offset:1024
    s_add_u32 s38, s38, 1
    s_and_b32 s38, s38, 7
    s_mul_i32 s48, s38, 5120
    s_waitcnt vmcnt(1)
    buffer_load_dwordx4 v[136:139], v4, s[40:43], s48 offen offset:0
    s_waitcnt vmcnt(1)
    buffer_load_dwordx4 v[144:147], v4, s[40:43], s48 offen offset:256
    s_waitcnt vmcnt(1)
    buffer_load_dwordx4 v[152:155], v4, s[40:43], s48 offen offset:512
    s_waitcnt vmcnt(1)
    buffer_load_dwordx4 v[160:163], v4, s[40:43], s48 offen offset:768
    s_waitcnt vmcnt(1)
    buffer_load_dwordx4 v[168:171], v4, s[40:43], s48 offen offset:1024
    s_add_u32 s38, s38, 1
    s_and_b32 s38, s38, 7
    s_mul_i32 s48, s38, 5120
    s_waitcnt vmcnt(1)
    buffer_load_dwordx4 v[140:143], v4, s[40:43], s48 offen offset:0
    s_waitcnt vmcnt(1)
    buffer_load_dwordx4 v[148:151], v4, s[40:43], s48 offen offset:256
    s_waitcnt vmcnt(1)
    buffer_load_dwordx4 v[156:159], v4, s[40:43], s48 offen offset:512
    s_waitcnt vmcnt(1)
    buffer_load_dwordx4 v[164:167], v4, s[40:43], s48 offen offset:768
    s_waitcnt vmcnt(1)
    buffer_load_dwordx4 v[172:175], v4, s[40:43], s48 offen offset:1024
    s_add_u32 s38, s38, 1
    s_and_b32 s38, s38, 7
    s_mul_i32 s48, s38, 5120
    s_waitcnt vmcnt(1)
    buffer_load_dwordx4 v[176:179], v4, s[40:43], s48 offen offset:0
    s_waitcnt vmcnt(1)
    buffer_load_dwordx4 v[184:187], v4, s[40:43], s48 offen offset:256
    s_waitcnt vmcnt(1)
    buffer_load_dwordx4 v[192:195], v4, s[40:43], s48 offen offset:512
    s_waitcnt vmcnt(1)
    buffer_load_dwordx4 v[200:203], v4, s[40:43], s48 offen offset:768
    s_waitcnt vmcnt(1)
    buffer_load_dwordx4 v[208:211], v4, s[40:43], s48 offen offset:1024
    s_add_u32 s38, s38, 1
    s_and_b32 s38, s38, 7
    s_mul_i32 s48, s38, 5120
    s_waitcnt vmcnt(1)
    buffer_load_dwordx4 v[180:183], v4, s[40:43], s48 offen offset:0
    s_waitcnt vmcnt(1)
    buffer_load_dwordx4 v[188:191], v4, s[40:43], s48 offen offset:256
    s_waitcnt vmcnt(1)
    buffer_load_dwordx4 v[196:199], v4, s[40:43], s48 offen offset:512
    s_waitcnt vmcnt(1)
    buffer_load_dwordx4 v[204:207], v4, s[40:43], s48 offen offset:768
    s_waitcnt vmcnt(1)
    buffer_load_dwordx4 v[212:215], v4, s[40:43], s48 offen offset:1024
    s_add_u32 s38, s38, 1
    s_and_b32 s38, s38, 7
    s_mul_i32 s48, s38, 5120
    s_waitcnt vmcnt(1)
    buffer_load_dwordx4 v[216:219], v4, s[40:43], s48 offen offset:0
    s_waitcnt vmcnt(1)
    buffer_load_dwordx4 v[224:227], v4, s[40:43], s48 offen offset:256
    s_waitcnt vmcnt(1)
    buffer_load_dwordx4 v[232:235], v4, s[40:43], s48 offen offset:512
    s_waitcnt vmcnt(1)
    buffer_load_dwordx4 v[240:243], v4, s[40:43], s48 offen offset:768
    s_waitcnt vmcnt(1)
    buffer_load_dwordx4 v[248:251], v4, s[40:43], s48 offen offset:1024
    s_add_u32 s38, s38, 1
    s_and_b32 s38, s38, 7
    s_mul_i32 s48, s38, 5120
    s_waitcnt vmcnt(1)
    buffer_load_dwordx4 v[220:223], v4, s[40:43], s48 offen offset:0
    s_waitcnt vmcnt(1)
    buffer_load_dwordx4 v[228:231], v4, s[40:43], s48 offen offset:256
    s_waitcnt vmcnt(1)
    buffer_load_dwordx4 v[236:239], v4, s[40:43], s48 offen offset:512
    s_waitcnt vmcnt(1)
    buffer_load_dwordx4 v[244:247], v4, s[40:43], s48 offen offset:768
    s_waitcnt vmcnt(1)
    buffer_load_dwordx4 v[252:255], v4, s[40:43], s48 offen offset:1024
    v_and_b32 v36, 7, v0
    v_lshlrev_b32 v31, 4, v36
    v_bfe_u32 v36, v0, 3, 1
    v_lshl_add_u32 v31, v36, 13, v31
    v_bfe_u32 v36, v0, 4, 1
    s_lshl_b32 s49, s33, 1
    v_add_u32 v36, s49, v36
    v_lshl_add_u32 v31, v36, 7, v31
    v_cmp_lt_u32 vcc, 4, v36
    v_mov_b32 v36, 0x10000
    s_nop 0
    v_cndmask_b32 v31, v31, v36, vcc
    s_lshl_b32 s49, s33, 10
    v_lshl_add_u32 v32, v0, 4, s49
    v_lshlrev_b32 v33, 1, v2
    v_lshrrev_b32 v36, 1, v1
    v_add3_u32 v33, v33, v36, s37
    v_and_b32 v33, 7, v33
    v_and_b32 v36, 1, v33
    v_lshrrev_b32 v33, 1, v33
    v_lshlrev_b32 v33, 4, v33
    v_lshl_add_u32 v33, v36, 8, v33
    v_and_b32 v36, 1, v1
    v_lshl_add_u32 v33, v36, 3, v33
    s_lshl_b32 s49, s33, 6
    v_add_u32 v33, s49, v33
    s_mul_i32 s49, s33, 3072
    v_lshl_add_u32 v34, v2, 4, s49
    v_lshl_add_u32 v34, v36, 9, v34
    s_waitcnt vmcnt(0)
    s_cmp_lg_u32 s33, 0
    s_cbranch_scc1 L_h_noctl
    s_lshr_b32 s52, s2, 6
    s_mul_i32 s52, s52, 4352
    s_add_u32 s52, s52, 917504
    s_mov_b64 exec, 1
    s_mov_b32 s66, 0x2b290901
    s_mov_b32 s67, 0xff7f3f3b
    s_mov_b32 s50, 1048576
L_wp2496:
    ds_read_b32 v41, v35 offset:2112
    s_waitcnt lgkmcnt(0)
    v_cmp_gt_i32 vcc, 6, v41
    s_nop 0
    s_cbranch_vccz L_wpd2496
    s_sleep 2
    s_sub_u32 s50, s50, 1
    s_cbranch_scc0 L_wp2496
L_wpd2496:
    s_mov_b32 s58, 1
    s_atomic_add s58, s[18:19], s52 glc
    s_mov_b32 s68, 0x65555443
    s_mov_b32 s69, 0x77766666
    s_mov_b32 s70, 0x88888777
    s_mov_b32 s71, 0xdba99998
    s_waitcnt lgkmcnt(0)
    s_sub_u32 s58, s58, 0
    s_max_i32 s60, s58, 0
    s_min_i32 s60, s60, 63
    s_lshr_b32 s60, s60, 1
    s_cmp_ge_u32 s60, 16
    s_cselect_b64 s[62:63], s[70:71], s[68:69]
    s_lshl_b32 s60, s60, 2
    s_lshr_b64 s[62:63], s[62:63], s60
    s_and_b32 s60, s62, 15
    s_sub_u32 s60, s60, 7
    s_abs_i32 s59, s60
    s_lshl_b32 s62, s59, 3
    s_sub_u32 s62, s62, 8
    s_lshr_b64 s[62:63], s[66:67], s62
    s_and_b32 s62, s62, 0xff
    s_cmp_eq_u32 s59, 0
    s_cselect_b32 s62, 0, s62
    s_lshl_b32 s63, s62, 8
    s_cmp_gt_i32 s60, 0
    s_cselect_b32 s62, s63, s62
    v_mov_b32 v46, s62
    s_add_i32 s60, s60, s61
    s_max_i32 s60, s60, -8
    s_min_i32 s60, s60, 8
    s_abs_i32 s59, s60
    s_lshl_b32 s62, s59, 3
    s_sub_u32 s62, s62, 8
    s_lshr_b64 s[62:63], s[66:67], s62
    s_and_b32 s62, s62, 0xff
    s_cmp_eq_u32 s59, 0
    s_cselect_b32 s62, 0, s62
    s_lshl_b32 s63, s62, 8
    s_cmp_gt_i32 s60, 0
    s_cselect_b32 s62, s63, s62
    v_mov_b32 v47, s62
    ds_write_b64 v35, v[46:47] offset:512
    s_mov_b32 s50, 1048576
L_wp2549:
    ds_read_b32 v41, v35 offset:2112
    s_waitcnt lgkmcnt(0)
    v_cmp_gt_i32 vcc, 11, v41
    s_nop 0
    s_cbranch_vccz L_wpd2549
    s_sleep 2
    s_sub_u32 s50, s50, 1
    s_cbranch_scc0 L_wp2549
L_wpd2549:
    s_mov_b32 s58, 1
    s_atomic_add s58, s[18:19], s52 glc
    s_mov_b32 s68, 0x66555443
    s_mov_b32 s69, 0x77776666
    s_mov_b32 s70, 0x88887777
    s_mov_b32 s71, 0xdba99988
    s_waitcnt lgkmcnt(0)
    s_sub_u32 s58, s58, 64
    s_max_i32 s60, s58, 0
    s_min_i32 s60, s60, 63
    s_lshr_b32 s60, s60, 1
    s_cmp_ge_u32 s60, 16
    s_cselect_b64 s[62:63], s[70:71], s[68:69]
    s_lshl_b32 s60, s60, 2
    s_lshr_b64 s[62:63], s[62:63], s60
    s_and_b32 s60, s62, 15
    s_sub_u32 s60, s60, 7
    s_abs_i32 s59, s60
    s_lshl_b32 s62, s59, 3
    s_sub_u32 s62, s62, 8
    s_lshr_b64 s[62:63], s[66:67], s62
    s_and_b32 s62, s62, 0xff
    s_cmp_eq_u32 s59, 0
    s_cselect_b32 s62, 0, s62
    s_lshl_b32 s63, s62, 8
    s_cmp_gt_i32 s60, 0
    s_cselect_b32 s62, s63, s62
    v_mov_b32 v46, s62
    s_add_i32 s60, s60, s61
    s_max_i32 s60, s60, -8
    s_min_i32 s60, s60, 8
    s_abs_i32 s59, s60
    s_lshl_b32 s62, s59, 3
    s_sub_u32 s62, s62, 8
    s_lshr_b64 s[62:63], s[66:67], s62
    s_and_b32 s62, s62, 0xff
    s_cmp_eq_u32 s59, 0
    s_cselect_b32 s62, 0, s62
    s_lshl_b32 s63, s62, 8
    s_cmp_gt_i32 s60, 0
    s_cselect_b32 s62, s63, s62
    v_mov_b32 v47, s62
    ds_write_b64 v35, v[46:47] offset:512
    s_mov_b32 s50, 1048576
L_wp2602:
    ds_read_b32 v41, v35 offset:2112
    s_waitcnt lgkmcnt(0)
    v_cmp_gt_i32 vcc, 14, v41
    s_nop 0
    s_cbranch_vccz L_wpd2602
    s_sleep 2
    s_sub_u32 s50, s50, 1
    s_cbranch_scc0 L_wp2602
L_wpd2602:
    s_mov_b32 s58, 1
    s_atomic_add s58, s[18:19], s52 glc
    s_mov_b32 s68, 0x55544332
    s_mov_b32 s69, 0x77766665
    s_mov_b32 s70, 0x98888777
    s_mov_b32 s71, 0xecbaa999
    s_waitcnt lgkmcnt(0)
    s_sub_u32 s58, s58, 128
    s_max_i32 s60, s58, 0
    s_min_i32 s60, s60, 63
    s_lshr_b32 s60, s60, 1
    s_cmp_ge_u32 s60, 16
    s_cselect_b64 s[62:63], s[70:71], s[68:69]
    s_lshl_b32 s60, s60, 2
    s_lshr_b64 s[62:63], s[62:63], s60
    s_and_b32 s60, s62, 15
    s_sub_u32 s60, s60, 7
    s_abs_i32 s59, s60
    s_lshl_b32 s62, s59, 3
    s_sub_u32 s62, s62, 8
    s_lshr_b64 s[62:63], s[66:67], s62
    s_and_b32 s62, s62, 0xff
    s_cmp_eq_u32 s59, 0
    s_cselect_b32 s62, 0, s62
    s_lshl_b32 s63, s62, 8
    s_cmp_gt_i32 s60, 0
    s_cselect_b32 s62, s63, s62
    v_mov_b32 v46, s62
    s_add_i32 s60, s60, s61
    s_max_i32 s60, s60, -8
    s_min_i32 s60, s60, 8
    s_abs_i32 s59, s60
    s_lshl_b32 s62, s59, 3
    s_sub_u32 s62, s62, 8
    s_lshr_b64 s[62:63], s[66:67], s62
    s_and_b32 s62, s62, 0xff
    s_cmp_eq_u32 s59, 0
    s_cselect_b32 s62, 0, s62
    s_lshl_b32 s63, s62, 8
    s_cmp_gt_i32 s60, 0
    s_cselect_b32 s62, s63, s62
    v_mov_b32 v47, s62
    ds_write_b64 v35, v[46:47] offset:512
    s_waitcnt lgkmcnt(0)
    s_branch L_h_b2
L_h_noctl:
    s_cmp_lg_u32 s33, 2
    s_cbranch_scc1 L_h_not2
    s_mov_b32 s50, 1048576
L_wp2660:
    ds_read_b32 v41, v35 offset:2112
    s_waitcnt lgkmcnt(0)
    v_cmp_gt_i32 vcc, 13, v41
    s_nop 0
    s_cbranch_vccz L_wpd2660
    s_sleep 8
    s_sub_u32 s50, s50, 1
    s_cbranch_scc0 L_wp2660
L_wpd2660:
    v_mov_b32 v50, 0
    s_mov_b32 s39, 1
    s_mov_b32 s89, 1
    s_branch L_waitfac
L_h_not2:
    s_cmp_lg_u32 s33, 3
    s_cbranch_scc1 L_h_not3
    s_mov_b32 s50, 1048576
L_wp2677:
    ds_read_b32 v41, v35 offset:2192
    s_waitcnt lgkmcnt(0)
    v_cmp_gt_i32 vcc, 0, v41
    s_nop 0
    s_cbranch_vccz L_wpd2677
    s_sleep 8
    s_sub_u32 s50, s50, 1
    s_cbranch_scc0 L_wp2677
L_wpd2677:
    s_mov_b32 s70, 0
    s_branch L_h_b2d
L_h_not3:
    s_mov_b32 s76, 0
    s_and_b32 s53, s2, 0xc4
    s_cbranch_scc1 L_w_done
    s_add_u32 s64, s18, 0x400000
    s_addc_u32 s65, s19, 0
    s_mov_b32 s68, 0
    s_load_dword s71, s[64:65], 0
    s_memtime s[72:73]
    s_waitcnt lgkmcnt(0)
    s_mul_i32 s67, s72, 0x9e3779b1
    s_lshr_b32 s67, s67, 11
L_w_loop:
    s_add_u32 s67, s67, 0x6d2b80
    s_and_b32 s69, s67, 0x1fdf80
    s_lshl_b32 s77, s68, 13
    s_and_b32 s77, s77, 0x2000
    s_or_b32 s69, s69, s77
    s_memtime s[72:73]
    s_waitcnt lgkmcnt(0)
    s_load_dword s71, s[64:65], s69
    s_waitcnt lgkmcnt(0)
    s_memtime s[74:75]
    s_waitcnt lgkmcnt(0)
    s_sub_u32 s74, s74, s72
    s_min_u32 s74, s74, 1800
    s_sub_u32 s76, s74, s76
    s_add_u32 s68, s68, 1
    s_cmp_lt_u32 s68, 28
    s_cbranch_scc1 L_w_loop
L_w_done:
    s_and_b32 s76, s76, 0x80000000
    s_xor_b32 s76, s76, s57
    s_mov_b64 exec, 15
    s_mov_b32 s50, 1048576
L_h_pollstat:
    ds_read_b64 v[36:37], v27 offset:2048
    s_waitcnt lgkmcnt(0)
    v_cmp_eq_u32 vcc, -1, v37
    s_nop 0
    s_cbranch_vccz L_h_gotstat
    s_sleep 8
    s_sub_u32 s50, s50, 1
    s_cbranch_scc0 L_h_pollstat
L_h_gotstat:
    s_lshl_b32 s49, s31, 5
    v_add_u32 v38, s49, v27
    global_store_dwordx2 v38, v[36:37], s[18:19] offset:0 sc1
    s_mov_b64 exec, -1
    v_lshlrev_b32 v43, 4, v0
    ds_read_b32 v41, v35 offset:2180
    ds_read_b128 v[64:67], v43 offset:6144
    ds_read_b128 v[68:71], v43 offset:7168
    s_lshl_b32 s49, s31, 11
    s_add_u32 s49, s49, 1048576
    v_add_u32 v39, s49, v43
    s_lshl_b32 s49, s31, 3
    s_add_u32 s49, s49, 8192
    v_mov_b32 v42, s49
    v_mov_b32 v44, s56
    v_mov_b32 v45, s76
    s_waitcnt lgkmcnt(0)
    v_readfirstlane_b32 s55, v41
    s_nop 0
    s_and_b32 s55, s55, 2
    s_cbranch_scc0 L_h_nosend
    global_store_dwordx4 v39, v[64:67], s[18:19] offset:0 sc1
    global_store_dwordx4 v39, v[68:71], s[18:19] offset:1024 sc1
L_h_nosend:
    s_mov_b64 exec, 1
    s_waitcnt vmcnt(0)
    global_store_dwordx2 v42, v[44:45], s[18:19] sc1
    s_cbranch_scc0 L_h_norecv
    s_mov_b32 s50, 1048576
L_wp2763:
    ds_read_b32 v41, v35 offset:2112
    s_waitcnt lgkmcnt(0)
    v_cmp_gt_i32 vcc, 10, v41
    s_nop 0
    s_cbranch_vccz L_wpd2763
    s_sleep 2
    s_sub_u32 s50, s50, 1
    s_cbranch_scc0 L_wp2763
L_wpd2763:
    s_xor_b32 s49, s49, 8
    s_load_dwordx2 s[60:61], s[18:19], s49
    v_mov_b32 v40, s49
    s_waitcnt lgkmcnt(0)
    s_xor_b64 s[60:61], s[60:61], s[56:57]
    s_lshl_b64 s[60:61], s[60:61], 1
    s_cbranch_scc0 L_h_gotx
    s_mov_b32 s50, 1048576
L_h_pollx:
    global_load_dwordx2 v[46:47], v40, s[18:19] sc1
    s_waitcnt vmcnt(0)
    v_xor_b32 v46, s56, v46
    v_xor_b32 v47, s57, v47
    v_lshl_or_b32 v46, v47, 1, v46
    v_cmp_ne_u32 vcc, 0, v46
    s_nop 0
    s_cbranch_vccz L_h_gotx
    s_sleep 4
    s_sub_u32 s50, s50, 1
    s_cbranch_scc0 L_h_pollx
L_h_gotx:
    s_mov_b64 exec, -1
    v_xor_b32 v39, 0x800, v39
    global_load_dwordx4 v[64:67], v39, s[18:19] offset:0 sc1
    global_load_dwordx4 v[68:71], v39, s[18:19] offset:1024 sc1
    s_waitcnt vmcnt(1)
    ds_write_b128 v43, v[64:67] offset:6144
    s_waitcnt vmcnt(0)
    ds_write_b128 v43, v[68:71] offset:7168
    ds_write_b32 v35, v35 offset:2184
L_h_norecv:
    s_mov_b64 exec, -1
    s_mov_b32 s50, 1048576
L_wp2804:
    ds_read_b32 v41, v35 offset:2112
    s_waitcnt lgkmcnt(0)
    v_cmp_gt_i32 vcc, 11, v41
    s_nop 0
    s_cbranch_vccz L_wpd2804
    s_sleep 8
    s_sub_u32 s50, s50, 1
    s_cbranch_scc0 L_wp2804
L_wpd2804:
    v_add_u32 v43, 8192, v43
    s_mov_b32 s50, 1048576
L_h_pollflag:
    global_load_dwordx4 v[64:67], v43, s[18:19] offset:0 sc1
    global_load_dwordx4 v[68:71], v43, s[18:19] offset:1024 sc1
    s_waitcnt vmcnt(0)
    v_xor_b32 v64, s56, v64
    v_xor_b32 v65, s57, v65
    v_xor_b32 v66, s56, v66
    v_xor_b32 v67, s57, v67
    v_xor_b32 v68, s56, v68
    v_xor_b32 v69, s57, v69
    v_xor_b32 v70, s56, v70
    v_xor_b32 v71, s57, v71
    v_or3_b32 v64, v64, v66, v68
    v_or3_b32 v67, v67, v69, v71
    v_or_b32 v67, v67, v65
    v_lshlrev_b32 v67, 1, v67
    v_or3_b32 v64, v64, v70, v67
    v_cmp_ne_u32 vcc, 0, v64
    s_nop 0
    s_cbranch_vccz L_h_gotflag
    s_sleep 64
    s_sub_u32 s50, s50, 1
    s_cbranch_scc0 L_h_pollflag
L_h_gotflag:
    s_bfe_u32 s49, s31, 0x60001
    v_readlane_b32 s49, v65, s49
    s_nop 0
    s_lshr_b32 s49, s49, 31
    s_xor_b32 s49, s49, s27
    s_and_b32 s49, s49, 1
    v_mov_b32 v41, s49
    ds_write_b32 v35, v41 offset:2192
    v_mov_b32 v45, s57
    s_cmp_lg_u32 s31, 0
    s_cbranch_scc1 L_h_noepoch
    v_mov_b32 v42, 12288
    s_mov_b64 exec, 1
    global_store_dwordx2 v42, v[44:45], s[18:19] sc1
    s_mov_b64 exec, -1
L_h_noepoch:
    s_lshl_b32 s49, s30, 7
    v_lshl_add_u32 v38, v2, 3, s49
    global_load_dwordx2 v[36:37], v38, s[18:19] offset:0 sc1
    s_waitcnt vmcnt(0)
    v_mov_b32 v38, v36
    s_nop 1
    v_max_f32_dpp v38, v38, v38 row_ror:8 row_mask:0xf bank_mask:0xf
    s_nop 1
    v_max_f32_dpp v38, v38, v38 row_ror:4 row_mask:0xf bank_mask:0xf
    s_nop 1
    v_max_f32_dpp v38, v38, v38 row_ror:2 row_mask:0xf bank_mask:0xf
    s_nop 1
    v_max_f32_dpp v38, v38, v38 row_ror:1 row_mask:0xf bank_mask:0xf
    v_sub_f32 v36, v36, v38
    v_exp_f32 v36, v36
    s_nop 0
    v_mul_f32 v37, v37, v36
    s_nop 1
    v_add_f32_dpp v37, v37, v37 row_ror:8 row_mask:0xf bank_mask:0xf
    s_nop 1
    v_add_f32_dpp v37, v37, v37 row_ror:4 row_mask:0xf bank_mask:0xf
    s_nop 1
    v_add_f32_dpp v37, v37, v37 row_ror:2 row_mask:0xf bank_mask:0xf
    s_nop 1
    v_add_f32_dpp v37, v37, v37 row_ror:1 row_mask:0xf bank_mask:0xf
    v_rcp_f32 v38, v37
    s_nop 0
    v_fma_f32 v39, -v37, v38, 1.0
    v_fma_f32 v38, v39, v38, v38
    v_mul_f32 v36, v36, v38
    v_min_u32 v36, -2, v36
    v_and_b32 v38, 3, v0
    v_lshlrev_b32 v38, 3, v38
    s_lshl_b32 s49, s27, 2
    s_lshl_b64 exec, 15, s49
    ds_write_b32 v38, v36 offset:2208
    s_lshl_b32 s55, s55, 1
    s_xor_b32 s49, s49, s55
    s_lshl_b64 exec, 15, s49
    ds_write_b32 v38, v36 offset:2212
    s_waitcnt lgkmcnt(0)
L_h_b2:
    s_mov_b32 s70, -1
L_h_b2d:
    s_mov_b64 exec, -1
    s_mov_b32 s71, s70
    ds_read_b32 v41, v35 offset:2192
    s_lshr_b32 s76, s2, 4
    s_and_b32 s77, s2, 3
    s_lshl2_add_u32 s76, s76, s77
    s_cmp_ge_u32 s76, 5
    s_cselect_b32 s50, 261504, 0
    s_lshl_b32 s51, s76, 7
    s_add_u32 s50, s50, s51
    s_bfe_u32 s77, s2, 0x10003
    s_lshl_b32 s77, s77, 6
    s_add_u32 s50, s50, s77
    s_add_u32 s50, s50, 65536
    s_lshl1_add_u32 s51, s51, s77
    s_add_u32 s84, s18, s50
    s_addc_u32 s85, s19, 0
    s_mov_b32 s86, 262144
    s_mov_b32 s87, 0x20000
    v_bfe_u32 v54, v0, 2, 3
    v_lshlrev_b32 v54, 10, v54
    v_lshrrev_b32 v55, 5, v0
    v_lshl_add_u32 v54, v55, 14, v54
    v_and_b32 v55, 3, v0
    v_lshl_add_u32 v54, v55, 4, v54
    v_lshl_add_u32 v56, v55, 4, s51
    v_lshl_add_u32 v56, v1, 3, v56
    s_waitcnt lgkmcnt(0)
    v_and_b32 v41, 1, v41
    v_lshl_add_u32 v54, v41, 13, v54
    v_lshl_add_u32 v56, v41, 7, v56
    v_mov_b32 v57, 0x3f80
    v_mov_b64 v[50:51], 0
    v_mov_b64 v[52:53], 0
    v_mov_b32_dpp v50, v57 quad_perm:[0,1,2,3] row_mask:0xf bank_mask:1
    v_mov_b32_dpp v51, v57 quad_perm:[0,1,2,3] row_mask:0xf bank_mask:2
    v_mov_b32_dpp v52, v57 quad_perm:[0,1,2,3] row_mask:0xf bank_mask:1
    v_mov_b32_dpp v53, v57 quad_perm:[0,1,2,3] row_mask:0xf bank_mask:2
    s_mov_b32 s21, 32768
    s_mov_b32 s22, 65536
    s_mov_b32 s23, 98304
    s_mov_b32 s24, 131072
    s_mov_b32 s25, 163840
    s_mov_b32 s26, 196608
    s_mov_b32 s27, 229376
    s_mov_b64 s[52:53], s[70:71]
    s_and_b32 s76, s76, s70
    s_mov_b64 vcc, s[70:71]
    s_mov_b32 s50, 1048576
    v_mov_b64 v[10:11], 0
    v_mov_b64 v[12:13], 0
    v_mov_b64 v[14:15], 0
    v_mov_b64 v[16:17], 0
    v_mov_b64 v[18:19], 0
    v_mov_b64 v[20:21], 0
    v_mov_b64 v[22:23], 0
    v_mov_b64 v[24:25], 0
    v_mov_b64 v[64:65], 0
    v_mov_b64 v[66:67], 0
    v_mov_b64 v[68:69], 0
    v_mov_b64 v[70:71], 0
    v_mov_b64 v[72:73], 0
    v_mov_b64 v[74:75], 0
    v_mov_b64 v[76:77], 0
    v_mov_b64 v[78:79], 0
    v_mov_b64 v[80:81], 0
    v_mov_b64 v[82:83], 0
    s_cbranch_vccz L_nob2
    s_barrier
L_nob2:
    ds_read_b64 v[40:41], v33 offset:4096
    ds_read_b64 v[42:43], v33 offset:4608
    ds_read_b64 v[44:45], v33 offset:5120
    ds_read_b64 v[46:47], v33 offset:5632
    s_waitcnt lgkmcnt(2)
    v_pk_add_f32 v[40:41], v[40:41], v[42:43]
    s_waitcnt lgkmcnt(0)
    v_pk_add_f32 v[44:45], v[44:45], v[46:47]
    v_pk_add_f32 v[40:41], v[40:41], v[44:45]
    v_and_b32 v42, 0xffff0000, v40
    v_and_b32 v43, 0xffff0000, v41
    v_sub_f32 v40, v40, v42
    v_sub_f32 v41, v41, v43
    v_cvt_pk_bf16_f32 v40, v40, v42
    v_cvt_pk_bf16_f32 v41, v41, v43
    s_nop 0
    v_mov_b32_dpp v10, v40 row_newbcast:0 row_mask:0xf bank_mask:1
    v_mov_b32_dpp v11, v40 row_newbcast:0 row_mask:0xf bank_mask:2
    v_mov_b32_dpp v12, v41 row_newbcast:0 row_mask:0xf bank_mask:1
    v_mov_b32_dpp v13, v41 row_newbcast:0 row_mask:0xf bank_mask:2
    s_nop 1
    v_smfmac_f32_16x16x64_bf16 v[64:67], v[10:13], v[96:103], v58
    v_mov_b32_dpp v14, v40 row_newbcast:1 row_mask:0xf bank_mask:1
    v_mov_b32_dpp v15, v40 row_newbcast:1 row_mask:0xf bank_mask:2
    v_smfmac_f32_16x16x64_bf16 v[68:71], v[10:13], v[104:111], v58
    v_mov_b32_dpp v16, v41 row_newbcast:1 row_mask:0xf bank_mask:1
    v_mov_b32_dpp v17, v41 row_newbcast:1 row_mask:0xf bank_mask:2
    v_smfmac_f32_16x16x64_bf16 v[72:75], v[10:13], v[112:119], v58
    v_mov_b32_dpp v18, v40 row_newbcast:2 row_mask:0xf bank_mask:1
    v_mov_b32_dpp v19, v40 row_newbcast:2 row_mask:0xf bank_mask:2
    v_smfmac_f32_16x16x64_bf16 v[76:79], v[10:13], v[120:127], v58
    v_mov_b32_dpp v20, v41 row_newbcast:2 row_mask:0xf bank_mask:1
    v_mov_b32_dpp v21, v41 row_newbcast:2 row_mask:0xf bank_mask:2
    v_smfmac_f32_16x16x64_bf16 v[80:83], v[10:13], v[128:135], v58
    v_mov_b32_dpp v22, v40 row_newbcast:3 row_mask:0xf bank_mask:1
    v_mov_b32_dpp v23, v40 row_newbcast:3 row_mask:0xf bank_mask:2
    v_smfmac_f32_16x16x64_bf16 v[64:67], v[14:17], v[136:143], v58
    v_mov_b32_dpp v24, v41 row_newbcast:3 row_mask:0xf bank_mask:1
    v_mov_b32_dpp v25, v41 row_newbcast:3 row_mask:0xf bank_mask:2
    v_smfmac_f32_16x16x64_bf16 v[64:67], v[18:21], v[176:183], v58
    s_nop 0
    v_smfmac_f32_16x16x64_bf16 v[64:67], v[22:25], v[216:223], v58
    v_smfmac_f32_16x16x64_bf16 v[68:71], v[14:17], v[144:151], v58
    s_nop 1
    v_smfmac_f32_16x16x64_bf16 v[68:71], v[18:21], v[184:191], v58
    s_nop 1
    v_smfmac_f32_16x16x64_bf16 v[68:71], v[22:25], v[224:231], v58
    s_mov_b32 exec_hi, 0
    ds_write_b128 v34, v[64:67] offset:8192
    s_mov_b32 exec_hi, -1
    v_smfmac_f32_16x16x64_bf16 v[72:75], v[14:17], v[152:159], v58
    s_nop 1
    v_smfmac_f32_16x16x64_bf16 v[72:75], v[18:21], v[192:199], v58
    s_nop 1
    v_smfmac_f32_16x16x64_bf16 v[72:75], v[22:25], v[232:239], v58
    s_mov_b32 exec_hi, 0
    ds_write_b128 v34, v[68:71] offset:8448
    s_mov_b32 exec_hi, -1
    v_smfmac_f32_16x16x64_bf16 v[76:79], v[14:17], v[160:167], v58
    s_nop 1
    v_smfmac_f32_16x16x64_bf16 v[76:79], v[18:21], v[200:207], v58
    s_nop 1
    v_smfmac_f32_16x16x64_bf16 v[76:79], v[22:25], v[240:247], v58
    s_mov_b32 exec_hi, 0
    ds_write_b128 v34, v[72:75] offset:9216
    s_mov_b32 exec_hi, -1
    v_smfmac_f32_16x16x64_bf16 v[80:83], v[14:17], v[168:175], v58
    s_nop 1
    v_smfmac_f32_16x16x64_bf16 v[80:83], v[18:21], v[208:215], v58
    s_nop 1
    v_smfmac_f32_16x16x64_bf16 v[80:83], v[22:25], v[248:255], v58
    s_mov_b32 exec_hi, 0
    ds_write_b128 v34, v[76:79] offset:9472
    s_mov_b32 exec_hi, -1
    s_mov_b32 exec_hi, 0
    s_nop 3
    ds_write_b128 v34, v[80:83] offset:10240
    s_mov_b64 exec, -1
    s_cmp_eq_u32 s33, 3
    s_cbranch_vccz L_nob3
    s_waitcnt lgkmcnt(0)
    s_barrier
L_nob3:
    ds_read_b128 v[64:67], v32 offset:8192
    ds_read_b128 v[68:71], v32 offset:11264
    ds_read_b128 v[72:75], v32 offset:14336
    ds_read_b128 v[76:79], v32 offset:17408
    s_waitcnt lgkmcnt(2)
    v_pk_add_f32 v[64:65], v[64:65], v[68:69]
    v_pk_add_f32 v[66:67], v[66:67], v[70:71]
    s_waitcnt lgkmcnt(1)
    v_pk_add_f32 v[64:65], v[64:65], v[72:73]
    v_pk_add_f32 v[66:67], v[66:67], v[74:75]
    s_waitcnt lgkmcnt(0)
    v_pk_add_f32 v[64:65], v[64:65], v[76:77]
    v_pk_add_f32 v[66:67], v[66:67], v[78:79]
    v_cvt_pk_bf16_f32 v64, v64, v65
    v_cvt_pk_bf16_f32 v65, v66, v67
    v_min_u32 v64, -2, v64
    v_min_u32 v65, -2, v65
    s_nop 0
    v_permlane32_swap_b32 v64, v66
    v_permlane32_swap_b32 v65, v67
    s_mov_b32 exec_hi, 0
    buffer_store_dwordx4 v[64:67], v31, s[44:47], 0 offen sc1
    s_cbranch_scc1 L_consumer
    s_endpgm
L_consumer:
    s_cmp_ge_u32 s76, 10
    s_cbranch_scc1 L_cons_end
L_cons_poll:
    s_mov_b64 exec, s[52:53]
    s_cbranch_execz L_cons_skip
    buffer_load_dwordx4 v[96:99], v54, s[84:87], 0 offen sc1
    buffer_load_dwordx4 v[100:103], v54, s[84:87], s21 offen sc1
    buffer_load_dwordx4 v[104:107], v54, s[84:87], s22 offen sc1
    buffer_load_dwordx4 v[108:111], v54, s[84:87], s23 offen sc1
    buffer_load_dwordx4 v[112:115], v54, s[84:87], s24 offen sc1
    buffer_load_dwordx4 v[116:119], v54, s[84:87], s25 offen sc1
    buffer_load_dwordx4 v[120:123], v54, s[84:87], s26 offen sc1
    buffer_load_dwordx4 v[124:127], v54, s[84:87], s27 offen sc1
L_cons_skip:
    s_mov_b64 exec, -1
    s_nop 0
    v_mov_b64 v[68:69], 0
    v_mov_b64 v[70:71], 0
    s_sub_u32 s50, s50, 1
    s_cbranch_scc1 L_cons_end
    s_waitcnt vmcnt(0)
    v_smfmac_f32_16x16x64_bf16 v[68:71], v[50:53], v[96:103], v58
    v_max3_u32 v80, v96, v100, v104
    v_smfmac_f32_16x16x64_bf16 v[68:71], v[50:53], v[104:111], v58
    v_max3_u32 v81, v108, v112, v116
    v_smfmac_f32_16x16x64_bf16 v[68:71], v[50:53], v[112:119], v58
    v_max3_u32 v80, v80, v120, v124
    v_smfmac_f32_16x16x64_bf16 v[68:71], v[50:53], v[120:127], v58
    v_max_u32 v80, v80, v81
    v_cmp_eq_u32 s[52:53], -1, v80
    s_nop 0
    s_and_b64 s[52:53], s[52:53], s[70:71]
    s_cbranch_scc1 L_cons_poll
    s_nop 2
    v_add_f32_dpp v68, v68, v68 row_ror:4 row_mask:0xf bank_mask:0xf
    v_add_f32_dpp v69, v69, v69 row_ror:4 row_mask:0xf bank_mask:0xf
    v_add_f32_dpp v70, v70, v70 row_ror:4 row_mask:0xf bank_mask:0xf
    v_add_f32_dpp v71, v71, v71 row_ror:4 row_mask:0xf bank_mask:0xf
    v_add_f32_dpp v68, v68, v68 row_ror:8 row_mask:0xf bank_mask:0xf
    v_add_f32_dpp v69, v69, v69 row_ror:8 row_mask:0xf bank_mask:0xf
    v_add_f32_dpp v70, v70, v70 row_ror:8 row_mask:0xf bank_mask:0xf
    v_add_f32_dpp v71, v71, v71 row_ror:8 row_mask:0xf bank_mask:0xf
    s_mov_b32 exec_lo, 0xf000f
    s_mov_b32 exec_hi, 0
    v_cmp_u_f32 vcc, v68, v70
    v_cvt_pk_bf16_f32 v72, v68, v69
    v_cvt_pk_bf16_f32 v73, v70, v71
    s_cmp_eq_u32 s70, 0
    s_cbranch_scc1 L_h_b2
    s_cbranch_vccnz L_cons_full
L_cons_ok:
    global_store_dwordx2 v56, v[72:73], s[14:15]
L_cons_end:
    s_endpgm
L_cons_full:
    s_mov_b64 exec, -1
    v_max3_u32 v80, v96, v97, v98
    v_max3_u32 v81, v100, v101, v102
    v_max3_u32 v82, v104, v105, v106
    v_max3_u32 v83, v108, v109, v110
    v_max3_u32 v84, v112, v113, v114
    v_max3_u32 v85, v116, v117, v118
    v_max3_u32 v86, v120, v121, v122
    v_max3_u32 v87, v124, v125, v126
    v_max_u32 v80, v80, v99
    v_max_u32 v81, v81, v103
    v_max_u32 v82, v82, v107
    v_max_u32 v83, v83, v111
    v_max_u32 v84, v84, v115
    v_max_u32 v85, v85, v119
    v_max_u32 v86, v86, v123
    v_max_u32 v87, v87, v127
    v_cmp_eq_u32 s[52:53], -1, v80
    v_cmp_eq_u32 s[54:55], -1, v81
    v_cmp_eq_u32 s[56:57], -1, v82
    v_cmp_eq_u32 s[58:59], -1, v83
    v_cmp_eq_u32 s[60:61], -1, v84
    v_cmp_eq_u32 s[62:63], -1, v85
    v_cmp_eq_u32 s[64:65], -1, v86
    v_cmp_eq_u32 s[66:67], -1, v87
    s_or_b64 s[68:69], s[52:53], s[54:55]
    s_or_b64 s[68:69], s[68:69], s[56:57]
    s_or_b64 s[68:69], s[68:69], s[58:59]
    s_or_b64 s[68:69], s[68:69], s[60:61]
    s_or_b64 s[68:69], s[68:69], s[62:63]
    s_or_b64 s[68:69], s[68:69], s[64:65]
    s_or_b64 s[68:69], s[68:69], s[66:67]
    s_mov_b64 s[52:53], s[68:69]
    s_cbranch_scc1 L_cons_poll
    s_mov_b32 exec_lo, 0xf000f
    s_mov_b32 exec_hi, 0
    s_branch L_cons_ok
L_end:
    s_endpgm
.section .rodata,"a"
.p2align 6
.amdhsa_kernel standalone__mha_block_cached__decode_kernel
  .amdhsa_next_free_vgpr 256
  .amdhsa_next_free_sgpr 96
  .amdhsa_accum_offset 256
  .amdhsa_group_segment_fixed_size 0
  .amdhsa_kernarg_size 64
  .amdhsa_user_sgpr_count 2
  .amdhsa_user_sgpr_kernarg_segment_ptr 1
  .amdhsa_system_sgpr_workgroup_id_x 1
.end_amdhsa_kernel
```
